```python
import torch

def _softmax(x, axis=-1):
    return torch.softmax(x, dim=axis)
def _gelu(x):
    return torch.nn.functional.gelu(x, approximate="tanh")
def _silu(x):
    return torch.nn.functional.silu(x)
def _sigmoid(x):
    return torch.sigmoid(x)
def _layernorm(x, axis=-1, eps=1e-5):
    m = x.mean(dim=axis, keepdim=True)
    v = x.var(dim=axis, keepdim=True, unbiased=False)
    return (x - m) / torch.sqrt(v + eps)
def _scatter_add(tgt, idx, src, axis=0):
    return tgt.clone().index_add_(axis, idx, src)
def _segment_sum(src, seg, n):
    out = torch.zeros((n,) + src.shape[1:], dtype=src.dtype)
    return out.index_add_(0, seg, src)
def _pad(x, pw):
    flat = tuple(v for pair in reversed(pw) for v in pair)
    return torch.nn.functional.pad(x, flat)

kernel_name = 'concat_heads__softmax_full_mha__ssm_conv_s4__prompt'

def setup_inputs():

    _w = (lambda a: (lambda t: t.to(torch.bfloat16) if t.is_floating_point() else t)(torch.as_tensor(a)))
    def _A_setup():
        B, S, D = 1, 2048, 512
        return {
            "x": _w((lambda *s: torch.randn(*s, dtype=torch.bfloat16) * 0.2)(B, S, D)),
            "wqkv": _w((lambda *s: torch.randn(*s, dtype=torch.bfloat16) * 0.2)(D, 3 * D)),
            "wo": _w((lambda *s: torch.randn(*s, dtype=torch.bfloat16) * 0.05)(D, D)),
        }
    _A_in = _A_setup()

    def _B_setup():
        B, L, D, N = 1, 2048, 512, 128
        A_re = -(lambda _x: torch.exp(torch.as_tensor(_x)))((lambda *s: torch.randn(*s, dtype=torch.bfloat16) * 6.4)(D, N))
        A_im = torch.pi * (lambda *s: torch.randn(*s, dtype=torch.bfloat16) * 0.1)(D, N)
        B_re = (lambda *s: torch.randn(*s, dtype=torch.bfloat16) * 0.2)(D, N)
        B_im = (lambda *s: torch.randn(*s, dtype=torch.bfloat16) * 0.2)(D, N)
        C_re = (lambda *s: torch.randn(*s, dtype=torch.bfloat16) * 0.2)(D, N)
        C_im = (lambda *s: torch.randn(*s, dtype=torch.bfloat16) * 0.2)(D, N)
        log_dt = (lambda *s: torch.randn(*s, dtype=torch.bfloat16) * 0.1)(D) * 0.5 - 4.0
        Dskip = (lambda *s: torch.randn(*s, dtype=torch.bfloat16) * 0.1)(D)
        return {
            "u": _w((lambda *s: torch.randn(*s, dtype=torch.bfloat16) * 0.05)(B, L, D)),
            "A_re": _w(A_re),
            "A_im": _w(A_im),
            "B_re": _w(B_re),
            "B_im": _w(B_im),
            "C_re": _w(C_re),
            "C_im": _w(C_im),
            "log_dt": _w(log_dt),
            "Dskip": _w(Dskip),
        }
    _B_in = _B_setup()

    return {
        "A_x": _A_in["x"],
        "A_wqkv": _A_in["wqkv"],
        "A_wo": _A_in["wo"],
        "B_u": _B_in["u"],
        "B_A_re": _B_in["A_re"],
        "B_A_im": _B_in["A_im"],
        "B_B_re": _B_in["B_re"],
        "B_B_im": _B_in["B_im"],
        "B_C_re": _B_in["C_re"],
        "B_C_im": _B_in["C_im"],
        "B_log_dt": _B_in["log_dt"],
        "B_Dskip": _B_in["Dskip"],
    }

def reference(A_x, A_wqkv, A_wo, B_u, B_A_re, B_A_im, B_B_re, B_B_im, B_C_re, B_C_im, B_log_dt, B_Dskip):
    def _A_ref(x, wqkv, wo):
        B, S, D = x.shape
        H = 32; Dh = D // H
        qkv = (lambda x, *d: x.permute(*d))((x @ wqkv).reshape(B, S, 3, H, Dh), 2, 0, 3, 1, 4)
        q, k, v = qkv[0], qkv[1], qkv[2]
        scale = Dh ** -0.5
        scores = torch.einsum("bhqd,bhkd->bhqk", q, k) * scale
        p = _softmax(scores, axis=-1)
        o = torch.einsum("bhqk,bhkd->bhqd", p, v)
        return (lambda x, *d: x.permute(*d))(o, 0, 2, 1, 3).reshape(B, S, D) @ wo

    def _B_ref(u, A_re, A_im, B_re, B_im, C_re, C_im, log_dt, Dskip):
        Bsz, L, D = u.shape
        dt = torch.exp(log_dt)[:, None]
        A = A_re + 1j * A_im
        Bc = B_re + 1j * B_im
        Cc = C_re + 1j * C_im
        logdA = dt * A
        dB = dt * Bc
        l = (lambda x, dt: x.to(dt))(torch.arange(L), A_re.dtype)
        P = torch.exp(logdA[:, :, None] * l[None, None, :])
        K = torch.einsum("dn,dnl,dn->dl", Cc, P, dB).real
        L2 = 2 * L
        Kp = _pad(K, ((0, 0), (0, L)))
        up = (lambda x, *d: x.permute(*d))(u, 0, 2, 1)
        up = _pad(up, ((0, 0), (0, 0), (0, L)))
        Kf = (lambda x, axes=(-2,-1): torch.fft.rfft2(x.float(), dim=axes))(Kp[:, None, :], axes=(-2, -1))
        Uf = (lambda x, axes=(-2,-1): torch.fft.rfft2(x.float(), dim=axes))(up[:, :, None, :], axes=(-2, -1))
        Yf = Uf * Kf[None, :, :, :]
        y = (lambda x, s, axes=(-2,-1): torch.fft.irfft2(x, s=s, dim=axes).to(torch.bfloat16))(Yf, (1, L2), axes=(-2, -1))[:, :, 0, :L]
        y = (lambda x, *d: x.permute(*d))(y, 0, 2, 1) + u * Dskip[None, None, :]
        return y

    a = _A_ref(A_x, A_wqkv, A_wo)
    b = _B_ref(B_u, B_A_re, B_A_im, B_B_re, B_B_im, B_C_re, B_C_im, B_log_dt, B_Dskip)
    return torch.concatenate([a, b], axis=-1)
```

```asm
; @launch kernel=fused_kernel grid=(256,1,1) block=(768,1,1) lds=163328
.amdgcn_target "amdgcn-amd-amdhsa--gfx950"
.text
.globl fused_kernel
.p2align 8
.type fused_kernel,@function
fused_kernel:
  s_cmp_ge_u32 s2, 256
  s_cbranch_scc1 L_end
  s_load_dwordx4 s[4:7], s[0:1], 0
  s_load_dwordx2 s[32:33], s[0:1], 112
  s_load_dwordx4 s[8:11], s[0:1], 16
  s_load_dwordx16 s[12:27], s[0:1], 32
  s_load_dwordx4 s[28:31], s[0:1], 96
  v_lshrrev_b32 v4, 6, v0
  v_and_b32 v1, 63, v0
  v_readfirstlane_b32 s3, v4
  v_mov_b32 v2, 163072
  v_mov_b32 v3, 1
  s_cmp_ge_u32 s3, 8
  s_cbranch_scc1 L_H
  v_mov_b32 v5, 0
  v_lshl_add_u32 v4, v1, 2, v2
  ds_write_b32 v4, v5
  s_waitcnt lgkmcnt(0)
  s_barrier
  s_cmp_lt_u32 s3, 4
  s_cbranch_scc1 L_G
  s_branch L_X
L_H:
  s_setprio 2
  v_lshrrev_b32 v4, 3, v1
  v_and_b32 v4, 3, v4
  v_lshrrev_b32 v5, 5, v1
  v_lshl_add_u32 v4, v5, 3, v4
  v_lshrrev_b32 v6, 4, v1
  v_and_b32 v7, 7, v1
  v_xor_b32 v6, v6, v7
  v_lshlrev_b32 v6, 4, v6
  v_lshl_add_u32 v8, v4, 10, v6
  v_xor_b32 v9, 64, v8
  v_add_u32 v9, 4096, v9
  v_bfe_u32 v4, v1, 2, 2
  v_lshl_add_u32 v4, v5, 2, v4
  v_mul_u32_u24 v4, 3072, v4
  v_bfe_u32 v5, v1, 4, 1
  v_lshl_add_u32 v4, v5, 6, v4
  v_and_b32 v5, 3, v1
  v_lshl_add_u32 v10, v5, 4, v4
  s_sub_u32 s51, s3, 8
  s_lshr_b32 s95, s2, 5
  s_lshl_b32 s95, s95, 2
  s_and_b32 s96, s2, 3
  s_add_u32 s95, s95, s96
  s_and_b32 s96, s2, 4
  s_bfe_u32 s68, s2, 0x20003
  s_add_u32 s96, s96, s68
  s_lshl_b32 s63, s95, 2
  s_add_u32 s63, s63, s51
  s_lshl_b32 s63, s63, 14
  s_lshl_b32 s64, s96, 7
  s_mul_i32 s50, s51, 49152
  s_add_u32 s64, s64, s50
  s_lshl_b32 s49, s51, 11
  s_add_u32 s49, s49, 65536
  s_lshl_b32 s48, s51, 12
  s_lshl_b32 s62, s96, 7
  s_lshl_b32 s50, s50, 1
  s_add_u32 s62, s62, s50
  s_mov_b32 s42, 0x200000
  s_mov_b32 s43, 0x20000
  s_mov_b32 s46, 1572864
  s_mov_b32 s47, 0x20000
  s_and_b32 s55, s2, 3
  s_lshl_b32 s55, s55, 1
  s_and_b32 s56, s2, 4
  s_add_u32 s55, s55, s56
  s_and_b32 s55, s55, 7
  s_mov_b32 s56, s55
  s_mov_b32 s57, s63
  s_mov_b32 s58, s64
  s_mov_b32 s59, s62
  s_mov_b32 s53, 0
  v_subrev_u32 v11, 4, v2
  s_waitcnt lgkmcnt(0)
  s_mov_b32 s40, s4
  s_mov_b32 s41, s5
  s_mov_b32 s44, s6
  s_mov_b32 s45, s7
  s_waitcnt lgkmcnt(0)
  s_add_u32 s68, s32, 12845056
  s_addc_u32 s69, s33, 0
  s_load_dwordx2 s[34:35], s[68:69], 0
  s_mov_b32 s36, s32
  s_mov_b32 s37, s33
  s_mov_b32 s38, 16777216
  s_mov_b32 s39, 0x20000
L_ha:
  s_lshl_b32 s63, s55, 7
  s_add_u32 s63, s63, s57
  s_mul_i32 s64, s55, 196608
  s_add_u32 s64, s64, s58
  s_add_u32 s55, s55, 1
  s_and_b32 s55, s55, 7
  s_add_u32 m0, s49, 0
  s_nop 0
  buffer_load_dwordx4 v8, s[40:43], s63 offen lds
  s_add_u32 m0, s49, 1024
  s_nop 0
  buffer_load_dwordx4 v9, s[40:43], s63 offen lds
  s_add_u32 m0, s48, 0
  s_add_u32 s65, s64, 1024
  buffer_load_dwordx4 v10, s[44:47], s65 offen lds
  s_add_u32 m0, s48, 1024
  s_add_u32 s65, s64, 25600
  buffer_load_dwordx4 v10, s[44:47], s65 offen lds
  s_add_u32 m0, s48, 2048
  s_add_u32 s65, s64, 2048
  buffer_load_dwordx4 v10, s[44:47], s65 offen lds
  s_add_u32 m0, s48, 3072
  s_add_u32 s65, s64, 26624
  buffer_load_dwordx4 v10, s[44:47], s65 offen lds
  s_add_u32 s63, s63, 128
  s_add_u32 s64, s64, 196608
  s_add_u32 s49, s49, 0x2000
  s_add_u32 s48, s48, 0x4000
  s_and_b32 s48, s48, 0xffff
  s_add_u32 s53, s53, 1
  s_cmp_gt_u32 s53, 2
  s_cbranch_scc1 L_ha2
  s_cmp_eq_u32 s53, 1
  s_cbranch_scc0 L_ha1
  s_barrier
  s_branch L_ha
L_ha1:
  s_mov_b32 s71, 0
  s_waitcnt lgkmcnt(0)
  s_add_u32 s34, s34, 1
L_ha2:
  v_add_u32 v11, 4, v11
  s_cmp_eq_u32 s71, 1
  s_cbranch_scc1 L_ha_s
  s_waitcnt vmcnt(6)
  s_mov_b64 exec, 1
  ds_add_u32 v11, v3 offset:0
  s_mov_b64 exec, -1
L_ha_s:
  s_mov_b32 s71, 0
  s_cmp_lt_u32 s53, 4
  s_cbranch_scc1 L_ha
  ds_read_b32 v4, v11 offset:48
  s_waitcnt lgkmcnt(0)
  v_readfirstlane_b32 s68, v4
  s_nop 0
  s_cmp_ge_u32 s68, 4
  s_cbranch_scc1 L_ha_n
  s_waitcnt vmcnt(0)
  s_mov_b64 exec, 1
  ds_add_u32 v11, v3 offset:4
  s_mov_b64 exec, -1
  s_mov_b32 s71, 1
  s_mov_b32 s70, 0x400000
Lsp1:
  s_sleep 1
  ds_read_b32 v4, v11 offset:48
  s_sub_u32 s70, s70, 1
  s_cbranch_scc1 Lok2
  s_waitcnt lgkmcnt(0)
  v_readfirstlane_b32 s68, v4
  s_nop 0
  s_cmp_lt_u32 s68, 4
  s_cbranch_scc1 Lsp1
Lok2:
L_ha_n:
  s_cmp_lt_u32 s53, 8
  s_cbranch_scc1 L_ha
L_hb:
  s_mul_i32 s62, s56, 196608
  s_add_u32 s62, s62, s59
  s_add_u32 s56, s56, 2
  s_and_b32 s56, s56, 7
  s_add_u32 m0, s48, 0
  s_add_u32 s65, s62, 0
  buffer_load_dwordx4 v10, s[44:47], s65 offen lds
  s_add_u32 m0, s48, 1024
  s_add_u32 s65, s62, 24576
  buffer_load_dwordx4 v10, s[44:47], s65 offen lds
  s_add_u32 m0, s48, 2048
  s_add_u32 s65, s62, 49152
  buffer_load_dwordx4 v10, s[44:47], s65 offen lds
  s_add_u32 m0, s48, 3072
  s_add_u32 s65, s62, 73728
  buffer_load_dwordx4 v10, s[44:47], s65 offen lds
  s_add_u32 s62, s62, 393216
  s_add_u32 s48, s48, 0x4000
  s_add_u32 s53, s53, 1
  v_add_u32 v11, 4, v11
  s_cmp_eq_u32 s71, 1
  s_cbranch_scc1 L_hb_s
  s_waitcnt vmcnt(4)
  s_mov_b64 exec, 1
  ds_add_u32 v11, v3 offset:0
  s_mov_b64 exec, -1
L_hb_s:
  s_mov_b32 s71, 0
  s_cmp_eq_u32 s53, 12
  s_cbranch_scc1 L_he
  ds_read_b32 v4, v11 offset:48
  s_waitcnt lgkmcnt(0)
  v_readfirstlane_b32 s68, v4
  s_nop 0
  s_cmp_ge_u32 s68, 4
  s_cbranch_scc1 L_hb_n
  s_waitcnt vmcnt(0)
  s_mov_b64 exec, 1
  ds_add_u32 v11, v3 offset:4
  s_mov_b64 exec, -1
  s_mov_b32 s71, 1
  s_mov_b32 s70, 0x400000
Lsp3:
  s_sleep 1
  ds_read_b32 v4, v11 offset:48
  s_sub_u32 s70, s70, 1
  s_cbranch_scc1 Lok4
  s_waitcnt lgkmcnt(0)
  v_readfirstlane_b32 s68, v4
  s_nop 0
  s_cmp_lt_u32 s68, 4
  s_cbranch_scc1 Lsp3
Lok4:
L_hb_n:
  s_branch L_hb
L_he:
  s_waitcnt vmcnt(0)
  s_mov_b64 exec, 1
  ds_add_u32 v2, v3 offset:44
  s_mov_b64 exec, -1
  s_setprio 2
  s_lshr_b32 s50, s51, 1
  s_and_b32 s53, s51, 1
  s_lshl_b32 s64, s2, 1
  s_add_u32 s64, s64, s50
  s_lshl_b32 s64, s64, 12
  s_lshl_b32 s65, s53, 11
  s_add_u32 s64, s64, s65
  s_add_u32 s64, s64, 10485760
  s_lshl_b32 s48, s2, 8
  s_add_u32 s48, s48, 12713984
  s_lshl_b32 s65, s53, 8
  s_mul_i32 s49, s50, 4608
  s_add_u32 s49, s49, 148160
  s_sub_u32 s49, s49, s65
  s_mul_i32 s66, s50, 8320
  s_add_u32 s66, s66, 134622
  s_sub_u32 s66, s66, s65
  v_and_b32 v8, 15, v1
  v_lshrrev_b32 v9, 4, v1
  v_lshlrev_b32 v10, 4, v9
  v_or_b32 v4, 1, v8
  v_lshlrev_b32 v4, 1, v4
  v_sub_u32 v4, v10, v4
  v_and_b32 v0, 1, v8
  v_xor_b32 v0, 1, v0
  v_mul_u32_u24 v0, 4160, v0
  v_add3_u32 v4, v4, v0, s66
  v_lshl_add_u32 v0, v8, 5, v10
  v_add_u32 v0, s49, v0
  v_subrev_u32 v5, 1024, v4
  v_subrev_u32 v6, 2048, v4
  v_subrev_u32 v7, 3072, v4
  v_mov_b32 v136, 0
  v_mov_b32 v137, 0
  v_mov_b32 v138, 0
  v_mov_b32 v139, 0
  v_mov_b32 v140, 0
  v_mov_b32 v141, 0
  v_mov_b32 v142, 0
  v_mov_b32 v143, 0
  v_mov_b32 v144, 0
  v_mov_b32 v145, 0
  v_mov_b32 v146, 0
  v_mov_b32 v147, 0
  v_mov_b32 v148, 0
  v_mov_b32 v149, 0
  v_mov_b32 v150, 0
  v_mov_b32 v151, 0
  v_mov_b32 v152, 0
  v_mov_b32 v153, 0
  v_mov_b32 v154, 0
  v_mov_b32 v155, 0
  v_mov_b32 v156, 0
  v_mov_b32 v157, 0
  v_mov_b32 v158, 0
  v_mov_b32 v159, 0
  v_mov_b32 v160, 0
  v_mov_b32 v161, 0
  v_mov_b32 v162, 0
  v_mov_b32 v163, 0
  v_mov_b32 v164, 0
  v_mov_b32 v165, 0
  v_mov_b32 v166, 0
  v_mov_b32 v167, 0
  s_lshl_b32 s67, s50, 2
  v_add_u32 v8, s67, v2
  s_mov_b32 s70, 0x400000
Lsp5:
  s_sleep 1
  ds_read_b32 v9, v8 offset:112
  s_sub_u32 s70, s70, 1
  s_cbranch_scc1 Lok6
  s_waitcnt lgkmcnt(0)
  v_readfirstlane_b32 s68, v9
  s_nop 0
  s_cmp_lt_u32 s68, 2
  s_cbranch_scc1 Lsp5
Lok6:
  ds_read2_b32 v[8:9], v4 offset0:128 offset1:129
  ds_read2_b32 v[10:11], v4 offset0:130 offset1:131
  ds_read_b128 v[68:71], v0 offset:3584
  ds_read_b128 v[64:67], v0 offset:3072
  ds_read_b128 v[60:63], v0 offset:2560
  ds_read_b128 v[56:59], v0 offset:2048
  ds_read_b128 v[52:55], v0 offset:1536
  ds_read_b128 v[48:51], v0 offset:1024
  ds_read_b128 v[44:47], v0 offset:512
  ds_read_b128 v[40:43], v0 offset:0
  ds_read2_b32 v[12:13], v4 offset0:0 offset1:1
  ds_read2_b32 v[14:15], v4 offset0:2 offset1:3
  ds_read2_b32 v[16:17], v5 offset0:128 offset1:129
  ds_read2_b32 v[18:19], v5 offset0:130 offset1:131
  ds_read2_b32 v[20:21], v5 offset0:0 offset1:1
  ds_read2_b32 v[22:23], v5 offset0:2 offset1:3
  ds_read2_b32 v[24:25], v6 offset0:128 offset1:129
  ds_read2_b32 v[26:27], v6 offset0:130 offset1:131
  ds_read2_b32 v[28:29], v6 offset0:0 offset1:1
  ds_read2_b32 v[30:31], v6 offset0:2 offset1:3
  ds_read2_b32 v[32:33], v7 offset0:128 offset1:129
  ds_read2_b32 v[34:35], v7 offset0:130 offset1:131
  ds_read2_b32 v[36:37], v7 offset0:0 offset1:1
  ds_read2_b32 v[38:39], v7 offset0:2 offset1:3
  v_subrev_u32 v4, 64, v4
  v_subrev_u32 v5, 64, v5
  v_subrev_u32 v6, 64, v6
  v_subrev_u32 v7, 64, v7
  v_subrev_u32 v0, 64, v0
  s_mov_b32 s66, 0
L_cl:
  s_waitcnt lgkmcnt(12)
  v_mfma_f32_16x16x32_bf16 v[164:167], v[8:11], v[68:71], v[164:167]
  v_mfma_f32_16x16x32_bf16 v[160:163], v[8:11], v[64:67], v[160:163]
  v_mfma_f32_16x16x32_bf16 v[156:159], v[8:11], v[60:63], v[156:159]
  v_mfma_f32_16x16x32_bf16 v[152:155], v[8:11], v[56:59], v[152:155]
  v_mfma_f32_16x16x32_bf16 v[148:151], v[8:11], v[52:55], v[148:151]
  v_mfma_f32_16x16x32_bf16 v[144:147], v[8:11], v[48:51], v[144:147]
  v_mfma_f32_16x16x32_bf16 v[140:143], v[8:11], v[44:47], v[140:143]
  v_mfma_f32_16x16x32_bf16 v[136:139], v[8:11], v[40:43], v[136:139]
  v_mfma_f32_16x16x32_bf16 v[164:167], v[12:15], v[64:67], v[164:167]
  v_mfma_f32_16x16x32_bf16 v[160:163], v[12:15], v[60:63], v[160:163]
  v_mfma_f32_16x16x32_bf16 v[156:159], v[12:15], v[56:59], v[156:159]
  v_mfma_f32_16x16x32_bf16 v[152:155], v[12:15], v[52:55], v[152:155]
  v_mfma_f32_16x16x32_bf16 v[148:151], v[12:15], v[48:51], v[148:151]
  v_mfma_f32_16x16x32_bf16 v[144:147], v[12:15], v[44:47], v[144:147]
  v_mfma_f32_16x16x32_bf16 v[140:143], v[12:15], v[40:43], v[140:143]
  s_waitcnt lgkmcnt(0)
  v_mfma_f32_16x16x32_bf16 v[164:167], v[16:19], v[60:63], v[164:167]
  ds_read2_b32 v[72:73], v4 offset0:128 offset1:129
  ds_read2_b32 v[74:75], v4 offset0:130 offset1:131
  v_mfma_f32_16x16x32_bf16 v[160:163], v[16:19], v[56:59], v[160:163]
  ds_read_b128 v[132:135], v0 offset:3584
  ds_read_b128 v[128:131], v0 offset:3072
  v_mfma_f32_16x16x32_bf16 v[156:159], v[16:19], v[52:55], v[156:159]
  ds_read_b128 v[124:127], v0 offset:2560
  ds_read_b128 v[120:123], v0 offset:2048
  v_mfma_f32_16x16x32_bf16 v[152:155], v[16:19], v[48:51], v[152:155]
  ds_read_b128 v[116:119], v0 offset:1536
  ds_read_b128 v[112:115], v0 offset:1024
  v_mfma_f32_16x16x32_bf16 v[148:151], v[16:19], v[44:47], v[148:151]
  ds_read_b128 v[108:111], v0 offset:512
  ds_read_b128 v[104:107], v0 offset:0
  v_mfma_f32_16x16x32_bf16 v[144:147], v[16:19], v[40:43], v[144:147]
  ds_read2_b32 v[76:77], v4 offset0:0 offset1:1
  ds_read2_b32 v[78:79], v4 offset0:2 offset1:3
  v_mfma_f32_16x16x32_bf16 v[164:167], v[20:23], v[56:59], v[164:167]
  ds_read2_b32 v[80:81], v5 offset0:128 offset1:129
  ds_read2_b32 v[82:83], v5 offset0:130 offset1:131
  v_mfma_f32_16x16x32_bf16 v[160:163], v[20:23], v[52:55], v[160:163]
  ds_read2_b32 v[84:85], v5 offset0:0 offset1:1
  ds_read2_b32 v[86:87], v5 offset0:2 offset1:3
  v_mfma_f32_16x16x32_bf16 v[156:159], v[20:23], v[48:51], v[156:159]
  ds_read2_b32 v[88:89], v6 offset0:128 offset1:129
  ds_read2_b32 v[90:91], v6 offset0:130 offset1:131
  v_mfma_f32_16x16x32_bf16 v[152:155], v[20:23], v[44:47], v[152:155]
  ds_read2_b32 v[92:93], v6 offset0:0 offset1:1
  ds_read2_b32 v[94:95], v6 offset0:2 offset1:3
  v_mfma_f32_16x16x32_bf16 v[148:151], v[20:23], v[40:43], v[148:151]
  ds_read2_b32 v[96:97], v7 offset0:128 offset1:129
  ds_read2_b32 v[98:99], v7 offset0:130 offset1:131
  v_mfma_f32_16x16x32_bf16 v[164:167], v[24:27], v[52:55], v[164:167]
  ds_read2_b32 v[100:101], v7 offset0:0 offset1:1
  ds_read2_b32 v[102:103], v7 offset0:2 offset1:3
  v_mfma_f32_16x16x32_bf16 v[160:163], v[24:27], v[48:51], v[160:163]
  v_subrev_u32 v4, 64, v4
  v_subrev_u32 v5, 64, v5
  v_mfma_f32_16x16x32_bf16 v[156:159], v[24:27], v[44:47], v[156:159]
  v_subrev_u32 v6, 64, v6
  v_subrev_u32 v7, 64, v7
  v_mfma_f32_16x16x32_bf16 v[152:155], v[24:27], v[40:43], v[152:155]
  v_subrev_u32 v0, 64, v0
  v_mfma_f32_16x16x32_bf16 v[164:167], v[28:31], v[48:51], v[164:167]
  v_mfma_f32_16x16x32_bf16 v[160:163], v[28:31], v[44:47], v[160:163]
  v_mfma_f32_16x16x32_bf16 v[156:159], v[28:31], v[40:43], v[156:159]
  v_mfma_f32_16x16x32_bf16 v[164:167], v[32:35], v[44:47], v[164:167]
  v_mfma_f32_16x16x32_bf16 v[160:163], v[32:35], v[40:43], v[160:163]
  v_mfma_f32_16x16x32_bf16 v[164:167], v[36:39], v[40:43], v[164:167]
  s_cmp_eq_u32 s66, 1
  s_cbranch_scc1 L_cl_last
  s_waitcnt lgkmcnt(12)
  v_mfma_f32_16x16x32_bf16 v[164:167], v[72:75], v[132:135], v[164:167]
  v_mfma_f32_16x16x32_bf16 v[160:163], v[72:75], v[128:131], v[160:163]
  v_mfma_f32_16x16x32_bf16 v[156:159], v[72:75], v[124:127], v[156:159]
  v_mfma_f32_16x16x32_bf16 v[152:155], v[72:75], v[120:123], v[152:155]
  v_mfma_f32_16x16x32_bf16 v[148:151], v[72:75], v[116:119], v[148:151]
  v_mfma_f32_16x16x32_bf16 v[144:147], v[72:75], v[112:115], v[144:147]
  v_mfma_f32_16x16x32_bf16 v[140:143], v[72:75], v[108:111], v[140:143]
  v_mfma_f32_16x16x32_bf16 v[136:139], v[72:75], v[104:107], v[136:139]
  v_mfma_f32_16x16x32_bf16 v[164:167], v[76:79], v[128:131], v[164:167]
  v_mfma_f32_16x16x32_bf16 v[160:163], v[76:79], v[124:127], v[160:163]
  v_mfma_f32_16x16x32_bf16 v[156:159], v[76:79], v[120:123], v[156:159]
  v_mfma_f32_16x16x32_bf16 v[152:155], v[76:79], v[116:119], v[152:155]
  v_mfma_f32_16x16x32_bf16 v[148:151], v[76:79], v[112:115], v[148:151]
  v_mfma_f32_16x16x32_bf16 v[144:147], v[76:79], v[108:111], v[144:147]
  v_mfma_f32_16x16x32_bf16 v[140:143], v[76:79], v[104:107], v[140:143]
  s_waitcnt lgkmcnt(0)
  v_mfma_f32_16x16x32_bf16 v[164:167], v[80:83], v[124:127], v[164:167]
  ds_read2_b32 v[8:9], v4 offset0:128 offset1:129
  ds_read2_b32 v[10:11], v4 offset0:130 offset1:131
  v_mfma_f32_16x16x32_bf16 v[160:163], v[80:83], v[120:123], v[160:163]
  ds_read_b128 v[68:71], v0 offset:3584
  ds_read_b128 v[64:67], v0 offset:3072
  v_mfma_f32_16x16x32_bf16 v[156:159], v[80:83], v[116:119], v[156:159]
  ds_read_b128 v[60:63], v0 offset:2560
  ds_read_b128 v[56:59], v0 offset:2048
  v_mfma_f32_16x16x32_bf16 v[152:155], v[80:83], v[112:115], v[152:155]
  ds_read_b128 v[52:55], v0 offset:1536
  ds_read_b128 v[48:51], v0 offset:1024
  v_mfma_f32_16x16x32_bf16 v[148:151], v[80:83], v[108:111], v[148:151]
  ds_read_b128 v[44:47], v0 offset:512
  ds_read_b128 v[40:43], v0 offset:0
  v_mfma_f32_16x16x32_bf16 v[144:147], v[80:83], v[104:107], v[144:147]
  ds_read2_b32 v[12:13], v4 offset0:0 offset1:1
  ds_read2_b32 v[14:15], v4 offset0:2 offset1:3
  v_mfma_f32_16x16x32_bf16 v[164:167], v[84:87], v[120:123], v[164:167]
  ds_read2_b32 v[16:17], v5 offset0:128 offset1:129
  ds_read2_b32 v[18:19], v5 offset0:130 offset1:131
  v_mfma_f32_16x16x32_bf16 v[160:163], v[84:87], v[116:119], v[160:163]
  ds_read2_b32 v[20:21], v5 offset0:0 offset1:1
  ds_read2_b32 v[22:23], v5 offset0:2 offset1:3
  v_mfma_f32_16x16x32_bf16 v[156:159], v[84:87], v[112:115], v[156:159]
  ds_read2_b32 v[24:25], v6 offset0:128 offset1:129
  ds_read2_b32 v[26:27], v6 offset0:130 offset1:131
  v_mfma_f32_16x16x32_bf16 v[152:155], v[84:87], v[108:111], v[152:155]
  ds_read2_b32 v[28:29], v6 offset0:0 offset1:1
  ds_read2_b32 v[30:31], v6 offset0:2 offset1:3
  v_mfma_f32_16x16x32_bf16 v[148:151], v[84:87], v[104:107], v[148:151]
  ds_read2_b32 v[32:33], v7 offset0:128 offset1:129
  ds_read2_b32 v[34:35], v7 offset0:130 offset1:131
  v_mfma_f32_16x16x32_bf16 v[164:167], v[88:91], v[116:119], v[164:167]
  ds_read2_b32 v[36:37], v7 offset0:0 offset1:1
  ds_read2_b32 v[38:39], v7 offset0:2 offset1:3
  v_mfma_f32_16x16x32_bf16 v[160:163], v[88:91], v[112:115], v[160:163]
  v_subrev_u32 v4, 64, v4
  v_subrev_u32 v5, 64, v5
  v_mfma_f32_16x16x32_bf16 v[156:159], v[88:91], v[108:111], v[156:159]
  v_subrev_u32 v6, 64, v6
  v_subrev_u32 v7, 64, v7
  v_mfma_f32_16x16x32_bf16 v[152:155], v[88:91], v[104:107], v[152:155]
  v_subrev_u32 v0, 64, v0
  v_mfma_f32_16x16x32_bf16 v[164:167], v[92:95], v[112:115], v[164:167]
  v_mfma_f32_16x16x32_bf16 v[160:163], v[92:95], v[108:111], v[160:163]
  v_mfma_f32_16x16x32_bf16 v[156:159], v[92:95], v[104:107], v[156:159]
  v_mfma_f32_16x16x32_bf16 v[164:167], v[96:99], v[108:111], v[164:167]
  v_mfma_f32_16x16x32_bf16 v[160:163], v[96:99], v[104:107], v[160:163]
  v_mfma_f32_16x16x32_bf16 v[164:167], v[100:103], v[104:107], v[164:167]
  s_add_u32 s66, s66, 1
  s_branch L_cl
L_cl_last:
  s_waitcnt lgkmcnt(12)
  v_mfma_f32_16x16x32_bf16 v[164:167], v[72:75], v[132:135], v[164:167]
  v_mfma_f32_16x16x32_bf16 v[160:163], v[72:75], v[128:131], v[160:163]
  v_mfma_f32_16x16x32_bf16 v[156:159], v[72:75], v[124:127], v[156:159]
  v_mfma_f32_16x16x32_bf16 v[152:155], v[72:75], v[120:123], v[152:155]
  v_mfma_f32_16x16x32_bf16 v[148:151], v[72:75], v[116:119], v[148:151]
  v_mfma_f32_16x16x32_bf16 v[144:147], v[72:75], v[112:115], v[144:147]
  v_mfma_f32_16x16x32_bf16 v[140:143], v[72:75], v[108:111], v[140:143]
  v_mfma_f32_16x16x32_bf16 v[136:139], v[72:75], v[104:107], v[136:139]
  v_mfma_f32_16x16x32_bf16 v[164:167], v[76:79], v[128:131], v[164:167]
  v_mfma_f32_16x16x32_bf16 v[160:163], v[76:79], v[124:127], v[160:163]
  v_mfma_f32_16x16x32_bf16 v[156:159], v[76:79], v[120:123], v[156:159]
  v_mfma_f32_16x16x32_bf16 v[152:155], v[76:79], v[116:119], v[152:155]
  v_mfma_f32_16x16x32_bf16 v[148:151], v[76:79], v[112:115], v[148:151]
  v_mfma_f32_16x16x32_bf16 v[144:147], v[76:79], v[108:111], v[144:147]
  v_mfma_f32_16x16x32_bf16 v[140:143], v[76:79], v[104:107], v[140:143]
  s_waitcnt lgkmcnt(0)
  v_mfma_f32_16x16x32_bf16 v[164:167], v[80:83], v[124:127], v[164:167]
  v_mfma_f32_16x16x32_bf16 v[160:163], v[80:83], v[120:123], v[160:163]
  v_mfma_f32_16x16x32_bf16 v[156:159], v[80:83], v[116:119], v[156:159]
  v_mfma_f32_16x16x32_bf16 v[152:155], v[80:83], v[112:115], v[152:155]
  v_mfma_f32_16x16x32_bf16 v[148:151], v[80:83], v[108:111], v[148:151]
  v_mfma_f32_16x16x32_bf16 v[144:147], v[80:83], v[104:107], v[144:147]
  v_mfma_f32_16x16x32_bf16 v[164:167], v[84:87], v[120:123], v[164:167]
  v_mfma_f32_16x16x32_bf16 v[160:163], v[84:87], v[116:119], v[160:163]
  v_mfma_f32_16x16x32_bf16 v[156:159], v[84:87], v[112:115], v[156:159]
  v_mfma_f32_16x16x32_bf16 v[152:155], v[84:87], v[108:111], v[152:155]
  v_mfma_f32_16x16x32_bf16 v[148:151], v[84:87], v[104:107], v[148:151]
  v_mfma_f32_16x16x32_bf16 v[164:167], v[88:91], v[116:119], v[164:167]
  v_mfma_f32_16x16x32_bf16 v[160:163], v[88:91], v[112:115], v[160:163]
  v_mfma_f32_16x16x32_bf16 v[156:159], v[88:91], v[108:111], v[156:159]
  v_mfma_f32_16x16x32_bf16 v[152:155], v[88:91], v[104:107], v[152:155]
  v_mfma_f32_16x16x32_bf16 v[164:167], v[92:95], v[112:115], v[164:167]
  v_mfma_f32_16x16x32_bf16 v[160:163], v[92:95], v[108:111], v[160:163]
  v_mfma_f32_16x16x32_bf16 v[156:159], v[92:95], v[104:107], v[156:159]
  v_mfma_f32_16x16x32_bf16 v[164:167], v[96:99], v[108:111], v[164:167]
  v_mfma_f32_16x16x32_bf16 v[160:163], v[96:99], v[104:107], v[160:163]
  v_mfma_f32_16x16x32_bf16 v[164:167], v[100:103], v[104:107], v[164:167]
  s_mul_i32 s66, s51, 6144
  s_add_u32 s66, s66, 40960
  s_xor_b32 s65, s51, 1
  s_mul_i32 s65, s65, 6144
  s_add_u32 s65, s65, 40960
  v_lshlrev_b32 v8, 4, v1
  v_add_u32 v9, s66, v8
  v_add_u32 v10, s65, v8
  v_add_u32 v11, s67, v2
  v_and_b32 v12, 15, v1
  v_lshlrev_b32 v12, 5, v12
  v_lshrrev_b32 v13, 4, v1
  v_lshl_add_u32 v12, v13, 3, v12
  v_add_u32 v12, s66, v12
  s_mov_b32 s70, 0x400000
Lsp7:
  ds_read_b32 v14, v2 offset:136
  s_sub_u32 s70, s70, 1
  s_cbranch_scc1 Lok8
  s_waitcnt lgkmcnt(0)
  v_readfirstlane_b32 s68, v14
  s_nop 0
  s_cmp_lt_u32 s68, 4
  s_cbranch_scc1 Lsp7
Lok8:
  s_cmp_eq_u32 s53, 0
  s_cbranch_scc1 L_cx0
  v_swap_b32 v136, v152
  v_swap_b32 v137, v153
  v_swap_b32 v138, v154
  v_swap_b32 v139, v155
  v_swap_b32 v140, v156
  v_swap_b32 v141, v157
  v_swap_b32 v142, v158
  v_swap_b32 v143, v159
  v_swap_b32 v144, v160
  v_swap_b32 v145, v161
  v_swap_b32 v146, v162
  v_swap_b32 v147, v163
  v_swap_b32 v148, v164
  v_swap_b32 v149, v165
  v_swap_b32 v150, v166
  v_swap_b32 v151, v167
L_cx0:
  ds_write_b128 v9, v[152:155] offset:0
  ds_write_b128 v9, v[156:159] offset:1024
  ds_write_b128 v9, v[160:163] offset:2048
  ds_write_b128 v9, v[164:167] offset:3072
  s_mov_b64 exec, 1
  ds_add_u32 v11, v3 offset:184
  s_mov_b64 exec, -1
  s_mov_b32 s70, 0x400000
Lsp9:
  ds_read_b32 v14, v11 offset:184
  s_sub_u32 s70, s70, 1
  s_cbranch_scc1 Lok10
  s_waitcnt lgkmcnt(0)
  v_readfirstlane_b32 s68, v14
  s_nop 0
  s_cmp_lt_u32 s68, 2
  s_cbranch_scc1 Lsp9
Lok10:
  ds_read_b128 v[16:19], v10 offset:0
  ds_read_b128 v[20:23], v10 offset:1024
  ds_read_b128 v[24:27], v10 offset:2048
  ds_read_b128 v[28:31], v10 offset:3072
  s_waitcnt lgkmcnt(0)
  v_add_f32 v16, v16, v136
  v_add_f32 v17, v17, v137
  v_add_f32 v18, v18, v138
  v_add_f32 v19, v19, v139
  v_add_f32 v20, v20, v140
  v_add_f32 v21, v21, v141
  v_add_f32 v22, v22, v142
  v_add_f32 v23, v23, v143
  v_add_f32 v24, v24, v144
  v_add_f32 v25, v25, v145
  v_add_f32 v26, v26, v146
  v_add_f32 v27, v27, v147
  v_add_f32 v28, v28, v148
  v_add_f32 v29, v29, v149
  v_add_f32 v30, v30, v150
  v_add_f32 v31, v31, v151
  v_cvt_pk_bf16_f32 v32, v16, v17
  v_cvt_pk_bf16_f32 v33, v18, v19
  ds_write_b64 v12, v[32:33] offset:4096
  v_cvt_pk_bf16_f32 v34, v20, v21
  v_cvt_pk_bf16_f32 v35, v22, v23
  ds_write_b64 v12, v[34:35] offset:4608
  v_cvt_pk_bf16_f32 v36, v24, v25
  v_cvt_pk_bf16_f32 v37, v26, v27
  ds_write_b64 v12, v[36:37] offset:5120
  v_cvt_pk_bf16_f32 v38, v28, v29
  v_cvt_pk_bf16_f32 v39, v30, v31
  ds_write_b64 v12, v[38:39] offset:5632
  ds_read_b128 v[40:43], v9 offset:4096
  ds_read_b128 v[44:47], v9 offset:5120
  s_waitcnt lgkmcnt(1)
  buffer_store_dwordx4 v[40:43], v8, s[36:39], s64 offen sc1
  s_waitcnt lgkmcnt(0)
  buffer_store_dwordx4 v[44:47], v8, s[36:39], s64 offen offset:1024 sc1
  s_setprio 1
  s_waitcnt vmcnt(0)
  s_mov_b64 exec, 1
  ds_add_rtn_u32 v48, v2, v3 offset:128
  v_mov_b32 v50, s34
  v_mov_b32 v51, s35
  v_mov_b32 v49, 0
  s_waitcnt lgkmcnt(0)
  v_readfirstlane_b32 s68, v48
  s_nop 0
  s_cmp_lg_u32 s68, 3
  s_cbranch_scc1 Lpb11
  buffer_store_dwordx2 v[50:51], v49, s[36:39], s48 offen sc1
Lpb11:
  s_mov_b64 exec, -1
  v_lshlrev_b32 v4, 4, v1
  v_lshlrev_b32 v5, 8, v1
  s_mov_b32 s52, s95
  s_mov_b32 s53, s96
  v_lshrrev_b32 v8, 2, v1
  v_and_b32 v9, 3, v1
  v_lshlrev_b32 v9, 4, v9
  v_lshl_add_u32 v10, v8, 10, v9
  v_lshl_add_u32 v11, v8, 12, v9
  s_lshl_b32 s55, s51, 17
  s_lshl_b32 s56, s53, 7
  s_add_u32 s55, s55, s56
  s_mov_b32 s40, s8
  s_mov_b32 s41, s9
  s_mov_b32 s42, 524288
  s_mov_b32 s43, 0x20000
  s_cmp_lg_u32 s51, 0
  s_cbranch_scc1 L_wpf
  v_lshrrev_b32 v8, 2, v1
  v_and_b32 v9, 3, v1
  v_lshlrev_b32 v9, 7, v9
  v_lshl_add_u32 v8, v8, 10, v9
  s_lshr_b32 s56, s2, 3
  s_lshl_b32 s56, s56, 14
  s_and_b32 s57, s2, 4
  s_lshl_b32 s57, s57, 7
  s_add_u32 s56, s56, s57
  buffer_load_dword v51, v8, s[40:43], s56 offen
L_wpf:
  v_mov_b32 v50, v10
  s_mov_b32 s54, s55
  v_lshrrev_b32 v6, 3, v1
  v_and_b32 v7, 7, v1
  v_lshlrev_b32 v7, 4, v7
  v_lshl_add_u32 v8, v6, 12, v7
  v_lshl_add_u32 v9, v6, 10, v7
  v_lshl_add_u32 v10, v6, 11, v7
  v_mul_u32_u24 v11, 144, v6
  v_add_u32 v11, v11, v7
  s_mul_i32 s49, s51, 2304
  s_add_u32 s49, s49, 131072
  v_add_u32 v12, s49, v11
  v_add_u32 v11, 9216, v12
  v_lshrrev_b32 v13, 2, v1
  v_mul_u32_u24 v13, 144, v13
  v_and_b32 v14, 3, v1
  v_lshl_add_u32 v13, v14, 3, v13
  s_lshl_b32 s56, s51, 5
  s_add_u32 s56, s56, 131072
  v_add_u32 v13, s56, v13
  v_and_b32 v14, 15, v1
  v_mul_u32_u24 v14, 144, v14
  v_lshrrev_b32 v15, 4, v1
  v_lshl_add_u32 v14, v15, 3, v14
  s_add_u32 s56, s49, 9216
  v_add_u32 v14, s56, v14
  s_lshl_b32 s56, s53, 2
  s_add_u32 s56, s56, s51
  s_lshl_b32 s58, s56, 16
  s_lshl_b32 s59, s52, 7
  s_add_u32 s58, s58, s59
  s_add_u32 s58, s58, 10485760
  s_add_u32 s59, s58, 0x8000
  s_lshl_b32 s60, s53, 7
  s_lshl_b32 s56, s52, 2
  s_add_u32 s56, s56, s51
  s_lshl_b32 s61, s56, 14
  s_add_u32 s61, s61, s60
  s_add_u32 s57, s61, 0x2000
  s_lshl_b32 s62, s56, 15
  s_add_u32 s62, s62, s60
  s_add_u32 s62, s62, 1024
  s_add_u32 s56, s62, 0x4000
  s_lshl_b32 s63, s53, 13
  s_add_u32 s63, s63, 12713984
  s_mov_b32 s40, s10
  s_mov_b32 s41, s11
  s_mov_b32 s42, 2097152
  s_mov_b32 s43, 0x20000
  s_mov_b32 s44, s26
  s_mov_b32 s45, s27
  s_mov_b32 s46, 1024
  s_mov_b32 s47, 0x20000
  buffer_load_dwordx4 v[16:19], v9, s[40:43], s61 offen
  buffer_load_dwordx4 v[20:23], v9, s[40:43], s57 offen
  buffer_load_dwordx4 v[24:27], v7, s[44:47], s60 offen
  s_mov_b32 s70, 0x400000
Lsp12:
  s_sleep 16
  ds_read_b32 v48, v2 offset:128
  s_sub_u32 s70, s70, 1
  s_cbranch_scc1 Lok13
  s_waitcnt lgkmcnt(0)
  v_readfirstlane_b32 s68, v48
  s_nop 0
  s_cmp_lt_u32 s68, 4
  s_cbranch_scc1 Lsp12
Lok13:
  s_mov_b32 s70, 0x40000
  s_mov_b32 exec_lo, 0xffffffff
  s_mov_b32 exec_hi, 0x0
  s_branch Lpi17
Lpf14:
  s_sleep 24
Lpi17:
  buffer_load_dwordx2 v[48:49], v5, s[36:39], s63 offen sc1
Lpc16:
  s_sub_u32 s70, s70, 1
  s_cbranch_scc1 Lpk15
  s_waitcnt vmcnt(0)
  v_cmp_eq_u64 vcc, s[34:35], v[48:49]
  s_nop 3
  s_cmp_eq_u64 vcc, exec
  s_cbranch_scc0 Lpf14
Lpk15:
  s_mov_b64 exec, -1
  s_setprio 1
  buffer_load_dwordx4 v[32:35], v8, s[36:39], s58 offen sc1
  buffer_load_dwordx4 v[36:39], v8, s[36:39], s59 offen sc1
  s_mov_b32 s44, s28
  s_mov_b32 s45, s29
  s_mov_b32 s46, 4194304
  s_mov_b32 s47, 0x20000
  v_lshlrev_b32 v40, 16, v16
  v_and_b32 v41, 0xffff0000, v16
  v_lshlrev_b32 v42, 16, v24
  v_and_b32 v43, 0xffff0000, v24
  v_mul_f32 v40, v40, v42
  v_mul_f32 v41, v41, v43
  v_cvt_pk_bf16_f32 v16, v40, v41
  v_lshlrev_b32 v40, 16, v17
  v_and_b32 v41, 0xffff0000, v17
  v_lshlrev_b32 v42, 16, v25
  v_and_b32 v43, 0xffff0000, v25
  v_mul_f32 v40, v40, v42
  v_mul_f32 v41, v41, v43
  v_cvt_pk_bf16_f32 v17, v40, v41
  v_lshlrev_b32 v40, 16, v18
  v_and_b32 v41, 0xffff0000, v18
  v_lshlrev_b32 v42, 16, v26
  v_and_b32 v43, 0xffff0000, v26
  v_mul_f32 v40, v40, v42
  v_mul_f32 v41, v41, v43
  v_cvt_pk_bf16_f32 v18, v40, v41
  v_lshlrev_b32 v40, 16, v19
  v_and_b32 v41, 0xffff0000, v19
  v_lshlrev_b32 v42, 16, v27
  v_and_b32 v43, 0xffff0000, v27
  v_mul_f32 v40, v40, v42
  v_mul_f32 v41, v41, v43
  v_cvt_pk_bf16_f32 v19, v40, v41
  v_lshlrev_b32 v40, 16, v20
  v_and_b32 v41, 0xffff0000, v20
  v_lshlrev_b32 v42, 16, v24
  v_and_b32 v43, 0xffff0000, v24
  v_mul_f32 v40, v40, v42
  v_mul_f32 v41, v41, v43
  v_cvt_pk_bf16_f32 v20, v40, v41
  v_lshlrev_b32 v40, 16, v21
  v_and_b32 v41, 0xffff0000, v21
  v_lshlrev_b32 v42, 16, v25
  v_and_b32 v43, 0xffff0000, v25
  v_mul_f32 v40, v40, v42
  v_mul_f32 v41, v41, v43
  v_cvt_pk_bf16_f32 v21, v40, v41
  v_lshlrev_b32 v40, 16, v22
  v_and_b32 v41, 0xffff0000, v22
  v_lshlrev_b32 v42, 16, v26
  v_and_b32 v43, 0xffff0000, v26
  v_mul_f32 v40, v40, v42
  v_mul_f32 v41, v41, v43
  v_cvt_pk_bf16_f32 v22, v40, v41
  v_lshlrev_b32 v40, 16, v23
  v_and_b32 v41, 0xffff0000, v23
  v_lshlrev_b32 v42, 16, v27
  v_and_b32 v43, 0xffff0000, v27
  v_mul_f32 v40, v40, v42
  v_mul_f32 v41, v41, v43
  v_cvt_pk_bf16_f32 v23, v40, v41
  s_waitcnt vmcnt(1)
  ds_write_b128 v12, v[32:35]
  s_waitcnt vmcnt(0)
  ds_write_b128 v12, v[36:39] offset:1152
  s_mov_b64 exec, 1
  ds_add_u32 v2, v3 offset:192
  s_mov_b64 exec, -1
  s_mov_b32 s70, 0x400000
Lsp18:
  s_sleep 2
  ds_read_b32 v48, v2 offset:192
  s_sub_u32 s70, s70, 1
  s_cbranch_scc1 Lok19
  s_waitcnt lgkmcnt(0)
  v_readfirstlane_b32 s68, v48
  s_nop 0
  s_cmp_lt_u32 s68, 4
  s_cbranch_scc1 Lsp18
Lok19:
  ds_read_b64_tr_b16 v[32:33], v13 offset:0
  ds_read_b64_tr_b16 v[34:35], v13 offset:2304
  ds_read_b64_tr_b16 v[36:37], v13 offset:4608
  ds_read_b64_tr_b16 v[38:39], v13 offset:6912
  s_waitcnt lgkmcnt(0)
  ds_write_b64 v14, v[32:33] offset:0
  ds_write_b64 v14, v[34:35] offset:32
  ds_write_b64 v14, v[36:37] offset:64
  ds_write_b64 v14, v[38:39] offset:96
  ds_read_b128 v[32:35], v11
  ds_read_b128 v[36:39], v11 offset:1152
  s_waitcnt lgkmcnt(0)
  v_lshlrev_b32 v40, 16, v16
  v_and_b32 v41, 0xffff0000, v16
  v_lshlrev_b32 v42, 16, v32
  v_and_b32 v43, 0xffff0000, v32
  v_add_f32 v40, v40, v42
  v_add_f32 v41, v41, v43
  v_cvt_pk_bf16_f32 v24, v40, v41
  v_lshlrev_b32 v40, 16, v17
  v_and_b32 v41, 0xffff0000, v17
  v_lshlrev_b32 v42, 16, v33
  v_and_b32 v43, 0xffff0000, v33
  v_add_f32 v40, v40, v42
  v_add_f32 v41, v41, v43
  v_cvt_pk_bf16_f32 v25, v40, v41
  v_lshlrev_b32 v40, 16, v18
  v_and_b32 v41, 0xffff0000, v18
  v_lshlrev_b32 v42, 16, v34
  v_and_b32 v43, 0xffff0000, v34
  v_add_f32 v40, v40, v42
  v_add_f32 v41, v41, v43
  v_cvt_pk_bf16_f32 v26, v40, v41
  v_lshlrev_b32 v40, 16, v19
  v_and_b32 v41, 0xffff0000, v19
  v_lshlrev_b32 v42, 16, v35
  v_and_b32 v43, 0xffff0000, v35
  v_add_f32 v40, v40, v42
  v_add_f32 v41, v41, v43
  v_cvt_pk_bf16_f32 v27, v40, v41
  v_lshlrev_b32 v40, 16, v20
  v_and_b32 v41, 0xffff0000, v20
  v_lshlrev_b32 v42, 16, v36
  v_and_b32 v43, 0xffff0000, v36
  v_add_f32 v40, v40, v42
  v_add_f32 v41, v41, v43
  v_cvt_pk_bf16_f32 v28, v40, v41
  v_lshlrev_b32 v40, 16, v21
  v_and_b32 v41, 0xffff0000, v21
  v_lshlrev_b32 v42, 16, v37
  v_and_b32 v43, 0xffff0000, v37
  v_add_f32 v40, v40, v42
  v_add_f32 v41, v41, v43
  v_cvt_pk_bf16_f32 v29, v40, v41
  v_lshlrev_b32 v40, 16, v22
  v_and_b32 v41, 0xffff0000, v22
  v_lshlrev_b32 v42, 16, v38
  v_and_b32 v43, 0xffff0000, v38
  v_add_f32 v40, v40, v42
  v_add_f32 v41, v41, v43
  v_cvt_pk_bf16_f32 v30, v40, v41
  v_lshlrev_b32 v40, 16, v23
  v_and_b32 v41, 0xffff0000, v23
  v_lshlrev_b32 v42, 16, v39
  v_and_b32 v43, 0xffff0000, v39
  v_add_f32 v40, v40, v42
  v_add_f32 v41, v41, v43
  v_cvt_pk_bf16_f32 v31, v40, v41
  buffer_store_dwordx4 v[24:27], v10, s[44:47], s62 offen sc1
  buffer_store_dwordx4 v[28:31], v10, s[44:47], s56 offen sc1
  v_mov_b32 v10, v50
  s_mov_b32 s55, s54
  s_mov_b32 s40, s8
  s_mov_b32 s41, s9
  s_mov_b32 s42, 524288
  s_mov_b32 s43, 0x20000
  s_mov_b32 s70, 0x400000
Lsp20:
  s_sleep 1
  ds_read_b32 v16, v2 offset:136
  s_sub_u32 s70, s70, 1
  s_cbranch_scc1 Lok21
  s_waitcnt lgkmcnt(0)
  v_readfirstlane_b32 s68, v16
  s_nop 0
  s_cmp_lt_u32 s68, 4
  s_cbranch_scc1 Lsp20
Lok21:
  s_lshl_b32 s49, s51, 14
  s_add_u32 s49, s49, 65536
  s_add_u32 m0, s49, 0
  s_add_u32 s56, s55, 0
  buffer_load_dwordx4 v10, s[40:43], s56 offen lds
  s_waitcnt vmcnt(1)
  s_add_u32 m0, s49, 1024
  s_add_u32 s56, s55, 64
  buffer_load_dwordx4 v10, s[40:43], s56 offen lds
  s_waitcnt vmcnt(1)
  s_add_u32 m0, s49, 2048
  s_add_u32 s56, s55, 16384
  buffer_load_dwordx4 v10, s[40:43], s56 offen lds
  s_waitcnt vmcnt(1)
  s_add_u32 m0, s49, 3072
  s_add_u32 s56, s55, 16448
  buffer_load_dwordx4 v10, s[40:43], s56 offen lds
  s_waitcnt vmcnt(1)
  s_add_u32 m0, s49, 4096
  s_add_u32 s56, s55, 32768
  buffer_load_dwordx4 v10, s[40:43], s56 offen lds
  s_waitcnt vmcnt(1)
  s_add_u32 m0, s49, 5120
  s_add_u32 s56, s55, 32832
  buffer_load_dwordx4 v10, s[40:43], s56 offen lds
  s_waitcnt vmcnt(1)
  s_add_u32 m0, s49, 6144
  s_add_u32 s56, s55, 49152
  buffer_load_dwordx4 v10, s[40:43], s56 offen lds
  s_waitcnt vmcnt(1)
  s_add_u32 m0, s49, 7168
  s_add_u32 s56, s55, 49216
  buffer_load_dwordx4 v10, s[40:43], s56 offen lds
  s_waitcnt vmcnt(1)
  s_add_u32 m0, s49, 8192
  s_add_u32 s56, s55, 65536
  buffer_load_dwordx4 v10, s[40:43], s56 offen lds
  s_waitcnt vmcnt(1)
  s_add_u32 m0, s49, 9216
  s_add_u32 s56, s55, 65600
  buffer_load_dwordx4 v10, s[40:43], s56 offen lds
  s_waitcnt vmcnt(1)
  s_add_u32 m0, s49, 10240
  s_add_u32 s56, s55, 81920
  buffer_load_dwordx4 v10, s[40:43], s56 offen lds
  s_waitcnt vmcnt(1)
  s_add_u32 m0, s49, 11264
  s_add_u32 s56, s55, 81984
  buffer_load_dwordx4 v10, s[40:43], s56 offen lds
  s_waitcnt vmcnt(1)
  s_add_u32 m0, s49, 12288
  s_add_u32 s56, s55, 98304
  buffer_load_dwordx4 v10, s[40:43], s56 offen lds
  s_waitcnt vmcnt(1)
  s_add_u32 m0, s49, 13312
  s_add_u32 s56, s55, 98368
  buffer_load_dwordx4 v10, s[40:43], s56 offen lds
  s_waitcnt vmcnt(1)
  s_add_u32 m0, s49, 14336
  s_add_u32 s56, s55, 114688
  buffer_load_dwordx4 v10, s[40:43], s56 offen lds
  s_waitcnt vmcnt(1)
  s_add_u32 m0, s49, 15360
  s_add_u32 s56, s55, 114752
  buffer_load_dwordx4 v10, s[40:43], s56 offen lds
  s_waitcnt vmcnt(1)
  s_waitcnt vmcnt(0)
  s_mov_b64 exec, 1
  ds_add_u32 v2, v3 offset:148
  s_mov_b64 exec, -1
L_end:
  s_endpgm
L_G:
  s_setprio 3
  s_lshr_b32 s95, s2, 5
  s_lshl_b32 s95, s95, 2
  s_and_b32 s96, s2, 3
  s_add_u32 s95, s95, s96
  s_and_b32 s96, s2, 4
  s_bfe_u32 s68, s2, 0x20003
  s_add_u32 s96, s96, s68
  s_and_b32 s56, s3, 1
  s_lshr_b32 s57, s3, 1
  v_and_b32 v4, 31, v1
  v_lshrrev_b32 v5, 5, v1
  v_bfe_u32 v6, v1, 1, 3
  v_xor_b32 v6, v6, v5
  v_lshlrev_b32 v4, 7, v4
  s_lshl_b32 s58, s56, 12
  s_add_u32 s58, s58, 65536
  v_add_u32 v4, s58, v4
  s_waitcnt lgkmcnt(0)
  s_add_u32 s68, s32, 12845056
  s_addc_u32 s69, s33, 0
  s_load_dwordx2 s[34:35], s[68:69], 0
  s_mov_b32 s36, s32
  s_mov_b32 s37, s33
  s_mov_b32 s38, 16777216
  s_mov_b32 s39, 0x20000
  v_xor_b32 v7, 0, v6
  v_lshl_add_u32 v8, v7, 4, v4
  v_xor_b32 v7, 2, v6
  v_lshl_add_u32 v9, v7, 4, v4
  v_xor_b32 v7, 4, v6
  v_lshl_add_u32 v10, v7, 4, v4
  v_xor_b32 v7, 6, v6
  v_lshl_add_u32 v11, v7, 4, v4
  v_lshlrev_b32 v4, 10, v5
  v_bfe_u32 v6, v1, 2, 2
  v_lshl_add_u32 v4, v6, 6, v4
  v_bfe_u32 v6, v1, 4, 1
  v_lshl_add_u32 v4, v6, 5, v4
  v_and_b32 v6, 3, v1
  v_lshl_add_u32 v4, v6, 3, v4
  s_lshl_b32 s58, s57, 8
  v_add_u32 v13, s58, v4
  s_mov_b32 s70, 0x400000
Lsp22:
  s_sleep 1
  ds_read_b32 v60, v2 offset:0
  s_sub_u32 s70, s70, 1
  s_cbranch_scc1 Lok23
  s_waitcnt lgkmcnt(0)
  v_readfirstlane_b32 s68, v60
  s_nop 0
  s_cmp_lt_u32 s68, 4
  s_cbranch_scc1 Lsp22
Lok23:
  s_waitcnt lgkmcnt(0)
  s_add_u32 s34, s34, 1
  ds_read_b32 v60, v2 offset:4
  ds_read_b128 v[16:19], v8 offset:0
  ds_read_b64_tr_b16 v[20:21], v13 offset:0
  ds_read_b64_tr_b16 v[22:23], v13 offset:512
  ds_read_b64_tr_b16 v[24:25], v13 offset:2048
  ds_read_b64_tr_b16 v[26:27], v13 offset:2560
  ds_read_b128 v[28:31], v9 offset:0
  ds_read_b64_tr_b16 v[32:33], v13 offset:4096
  ds_read_b64_tr_b16 v[34:35], v13 offset:4608
  ds_read_b64_tr_b16 v[36:37], v13 offset:6144
  ds_read_b64_tr_b16 v[38:39], v13 offset:6656
  ds_read_b128 v[40:43], v10 offset:0
  ds_read_b64_tr_b16 v[44:45], v13 offset:8192
  ds_read_b64_tr_b16 v[46:47], v13 offset:8704
  ds_read_b64_tr_b16 v[48:49], v13 offset:10240
  ds_read_b64_tr_b16 v[50:51], v13 offset:10752
  s_waitcnt lgkmcnt(10)
  v_mfma_f32_32x32x16_bf16 v[80:95], v[20:23], v[16:19], 0
  ds_read_b128 v[112:115], v11 offset:0
  ds_read_b64_tr_b16 v[116:117], v13 offset:12288
  ds_read_b64_tr_b16 v[118:119], v13 offset:12800
  ds_read_b64_tr_b16 v[120:121], v13 offset:14336
  ds_read_b64_tr_b16 v[122:123], v13 offset:14848
  v_mfma_f32_32x32x16_bf16 v[96:111], v[16:19], v[24:27], 0
  s_waitcnt lgkmcnt(10)
  v_lshlrev_b32 v52, 4, v1
  v_bfe_u32 v4, v1, 4, 1
  v_mul_u32_u24 v4, 65536, v4
  v_lshl_add_u32 v4, v5, 8, v4
  v_and_b32 v5, 15, v1
  v_lshl_add_u32 v53, v5, 4, v4
  s_lshl_b32 s58, s57, 2
  s_add_u32 s58, s58, s56
  s_lshl_b32 s58, s58, 10
  v_add_u32 v54, s58, v52
  s_and_b32 s60, s2, 3
  s_lshl_b32 s60, s60, 2
  s_lshr_b32 s61, s2, 6
  s_add_u32 s60, s60, s61
  s_lshl_b32 s60, s60, 1
  s_add_u32 s60, s60, s56
  s_lshl_b32 s60, s60, 10
  s_lshl_b32 s62, s96, 1
  s_add_u32 s62, s62, s57
  s_lshl_b32 s62, s62, 2
  s_bfe_u32 s63, s2, 0x10005
  s_add_u32 s62, s62, s63
  s_mul_i32 s62, s62, 32768
  s_add_u32 s62, s62, s60
  s_add_u32 s64, s62, 2097152
  s_add_u32 s65, s62, 2162688
  s_add_u32 s66, s62, 4718592
  s_mov_b32 s67, 0x3eb8aa3b
  s_lshl_b32 s49, s96, 2
  s_and_b32 s48, s2, 3
  s_add_u32 s49, s49, s48
  s_lshl_b32 s49, s49, 1
  s_bfe_u32 s48, s2, 0x10005
  s_add_u32 s49, s49, s48
  s_lshl_b32 s49, s49, 2
  s_add_u32 s49, s49, s61
  s_lshl_b32 s49, s49, 3
  s_lshl_b32 s49, s49, 5
  s_add_u32 s49, s49, 12648448
  s_and_b32 s55, s3, 3
  s_lshr_b32 s56, s3, 2
  s_lshl_b32 s52, s96, 2
  s_add_u32 s52, s52, s55
  s_lshl_b32 s58, s52, 1
  s_add_u32 s58, s58, s56
  s_mul_i32 s58, s58, 32768
  s_add_u32 s62, s58, 2097152
  s_add_u32 s58, s58, 4718592
  s_lshl_b32 s53, s96, 13
  s_add_u32 s53, s53, 12648448
  v_and_b32 v5, 51, v1
  v_bfe_u32 v162, v1, 3, 1
  v_lshl_add_u32 v5, v162, 2, v5
  v_bfe_u32 v162, v1, 2, 1
  v_lshl_add_u32 v5, v162, 3, v5
  v_lshlrev_b32 v5, 4, v5
  v_and_b32 v162, 15, v1
  v_lshlrev_b32 v162, 4, v162
  v_lshrrev_b32 v163, 5, v1
  v_lshl_add_u32 v162, v163, 8, v162
  v_add_u32 v166, 2621440, v162
  v_and_b32 v163, 27, v1
  v_cmp_eq_u32 vcc, 16, v163
  v_mov_b32 v164, 0x3f803f80
  s_mov_b32 s50, 0xffff
  s_mov_b32 s51, 0xffff
  v_cndmask_b32 v164, 0, v164, vcc
  v_mov_b32 v128, v164
  v_mov_b32 v129, v164
  v_mov_b32 v130, v164
  v_mov_b32 v131, v164
  v_mov_b32 v132, v164
  v_mov_b32 v133, v164
  v_mov_b32 v134, v164
  v_mov_b32 v135, v164
  v_mov_b32 v136, v164
  v_mov_b32 v137, v164
  v_mov_b32 v138, v164
  v_mov_b32 v139, v164
  v_mov_b32 v140, v164
  v_mov_b32 v141, v164
  v_mov_b32 v142, v164
  v_mov_b32 v143, v164
  v_mov_b32 v144, v164
  v_mov_b32 v145, v164
  v_mov_b32 v146, v164
  v_mov_b32 v147, v164
  v_mov_b32 v148, v164
  v_mov_b32 v149, v164
  v_mov_b32 v150, v164
  v_mov_b32 v151, v164
  v_mov_b32 v152, v164
  v_mov_b32 v153, v164
  v_mov_b32 v154, v164
  v_mov_b32 v155, v164
  v_mov_b32 v156, v164
  v_mov_b32 v157, v164
  v_mov_b32 v158, v164
  v_mov_b32 v159, v164
  v_mov_b32 v4, 0xdddddddd
  v_lshlrev_b32 v167, 4, v1
  s_lshl_b32 s60, s95, 3
  s_add_u32 s60, s60, s96
  s_lshl_b32 s60, s60, 8
  s_add_u32 s60, s60, 12779520
  s_cmp_lt_u32 s3, 4
  s_cselect_b32 s54, 8, 6
  v_readfirstlane_b32 s68, v60
  s_nop 0
  s_cmp_ge_u32 s68, 4
  s_cbranch_scc1 Lok25
  s_mov_b32 s70, 0x400000
Lsp24:
  ds_read_b32 v60, v2 offset:4
  s_sub_u32 s70, s70, 1
  s_cbranch_scc1 Lok25
  s_waitcnt lgkmcnt(0)
  v_readfirstlane_b32 s68, v60
  s_nop 0
  s_cmp_lt_u32 s68, 4
  s_cbranch_scc1 Lsp24
Lok25:
  v_mfma_f32_32x32x16_bf16 v[80:95], v[32:35], v[28:31], v[80:95]
  ds_read_b128 v[16:19], v8 offset:8192
  ds_read_b64_tr_b16 v[20:21], v13 offset:16384
  ds_read_b64_tr_b16 v[22:23], v13 offset:16896
  ds_read_b64_tr_b16 v[24:25], v13 offset:18432
  ds_read_b64_tr_b16 v[26:27], v13 offset:18944
  v_mfma_f32_32x32x16_bf16 v[96:111], v[28:31], v[36:39], v[96:111]
  s_waitcnt lgkmcnt(10)
  v_mfma_f32_32x32x16_bf16 v[80:95], v[44:47], v[40:43], v[80:95]
  ds_read_b32 v60, v2 offset:8
  ds_read_b128 v[28:31], v9 offset:8192
  ds_read_b64_tr_b16 v[32:33], v13 offset:20480
  ds_read_b64_tr_b16 v[34:35], v13 offset:20992
  ds_read_b64_tr_b16 v[36:37], v13 offset:22528
  ds_read_b64_tr_b16 v[38:39], v13 offset:23040
  v_mfma_f32_32x32x16_bf16 v[96:111], v[40:43], v[48:51], v[96:111]
  s_waitcnt lgkmcnt(10)
  s_mov_b64 exec, 1
  ds_add_u32 v2, v3 offset:56
  s_mov_b64 exec, -1
  v_mfma_f32_32x32x16_bf16 v[80:95], v[116:119], v[112:115], v[80:95]
  ds_read_b128 v[40:43], v10 offset:8192
  ds_read_b64_tr_b16 v[44:45], v13 offset:24576
  ds_read_b64_tr_b16 v[46:47], v13 offset:25088
  ds_read_b64_tr_b16 v[48:49], v13 offset:26624
  ds_read_b64_tr_b16 v[50:51], v13 offset:27136
  v_mfma_f32_32x32x16_bf16 v[96:111], v[112:115], v[120:123], v[96:111]
  s_waitcnt lgkmcnt(10)
  v_mfma_f32_32x32x16_bf16 v[80:95], v[20:23], v[16:19], v[80:95]
  ds_read_b128 v[112:115], v11 offset:8192
  ds_read_b64_tr_b16 v[116:117], v13 offset:28672
  ds_read_b64_tr_b16 v[118:119], v13 offset:29184
  ds_read_b64_tr_b16 v[120:121], v13 offset:30720
  ds_read_b64_tr_b16 v[122:123], v13 offset:31232
  v_mfma_f32_32x32x16_bf16 v[96:111], v[16:19], v[24:27], v[96:111]
  s_waitcnt lgkmcnt(10)
  v_readfirstlane_b32 s68, v60
  s_nop 0
  s_cmp_ge_u32 s68, 4
  s_cbranch_scc1 Lok27
  s_mov_b32 s70, 0x400000
Lsp26:
  ds_read_b32 v60, v2 offset:8
  s_sub_u32 s70, s70, 1
  s_cbranch_scc1 Lok27
  s_waitcnt lgkmcnt(0)
  v_readfirstlane_b32 s68, v60
  s_nop 0
  s_cmp_lt_u32 s68, 4
  s_cbranch_scc1 Lsp26
Lok27:
  v_mfma_f32_32x32x16_bf16 v[80:95], v[32:35], v[28:31], v[80:95]
  ds_read_b128 v[16:19], v8 offset:16384
  ds_read_b64_tr_b16 v[20:21], v13 offset:32768
  ds_read_b64_tr_b16 v[22:23], v13 offset:33280
  ds_read_b64_tr_b16 v[24:25], v13 offset:34816
  ds_read_b64_tr_b16 v[26:27], v13 offset:35328
  v_mfma_f32_32x32x16_bf16 v[96:111], v[28:31], v[36:39], v[96:111]
  s_waitcnt lgkmcnt(10)
  v_mfma_f32_32x32x16_bf16 v[80:95], v[44:47], v[40:43], v[80:95]
  ds_read_b32 v60, v2 offset:12
  ds_read_b128 v[28:31], v9 offset:16384
  ds_read_b64_tr_b16 v[32:33], v13 offset:36864
  ds_read_b64_tr_b16 v[34:35], v13 offset:37376
  ds_read_b64_tr_b16 v[36:37], v13 offset:38912
  ds_read_b64_tr_b16 v[38:39], v13 offset:39424
  v_mfma_f32_32x32x16_bf16 v[96:111], v[40:43], v[48:51], v[96:111]
  s_waitcnt lgkmcnt(10)
  s_mov_b64 exec, 1
  ds_add_u32 v2, v3 offset:60
  s_mov_b64 exec, -1
  v_mfma_f32_32x32x16_bf16 v[80:95], v[116:119], v[112:115], v[80:95]
  ds_read_b128 v[40:43], v10 offset:16384
  ds_read_b64_tr_b16 v[44:45], v13 offset:40960
  ds_read_b64_tr_b16 v[46:47], v13 offset:41472
  ds_read_b64_tr_b16 v[48:49], v13 offset:43008
  ds_read_b64_tr_b16 v[50:51], v13 offset:43520
  v_mfma_f32_32x32x16_bf16 v[96:111], v[112:115], v[120:123], v[96:111]
  s_waitcnt lgkmcnt(10)
  v_mfma_f32_32x32x16_bf16 v[80:95], v[20:23], v[16:19], v[80:95]
  ds_read_b128 v[112:115], v11 offset:16384
  ds_read_b64_tr_b16 v[116:117], v13 offset:45056
  ds_read_b64_tr_b16 v[118:119], v13 offset:45568
  ds_read_b64_tr_b16 v[120:121], v13 offset:47104
  ds_read_b64_tr_b16 v[122:123], v13 offset:47616
  v_mfma_f32_32x32x16_bf16 v[96:111], v[16:19], v[24:27], v[96:111]
  s_waitcnt lgkmcnt(10)
  v_readfirstlane_b32 s68, v60
  s_nop 0
  s_cmp_ge_u32 s68, 4
  s_cbranch_scc1 Lok29
  s_mov_b32 s70, 0x400000
Lsp28:
  ds_read_b32 v60, v2 offset:12
  s_sub_u32 s70, s70, 1
  s_cbranch_scc1 Lok29
  s_waitcnt lgkmcnt(0)
  v_readfirstlane_b32 s68, v60
  s_nop 0
  s_cmp_lt_u32 s68, 4
  s_cbranch_scc1 Lsp28
Lok29:
  v_mfma_f32_32x32x16_bf16 v[80:95], v[32:35], v[28:31], v[80:95]
  ds_read_b128 v[16:19], v8 offset:24576
  ds_read_b64_tr_b16 v[20:21], v13 offset:49152
  ds_read_b64_tr_b16 v[22:23], v13 offset:49664
  ds_read_b64_tr_b16 v[24:25], v13 offset:51200
  ds_read_b64_tr_b16 v[26:27], v13 offset:51712
  v_mfma_f32_32x32x16_bf16 v[96:111], v[28:31], v[36:39], v[96:111]
  s_waitcnt lgkmcnt(10)
  v_mfma_f32_32x32x16_bf16 v[80:95], v[44:47], v[40:43], v[80:95]
  ds_read_b32 v60, v2 offset:16
  ds_read_b128 v[28:31], v9 offset:24576
  ds_read_b64_tr_b16 v[32:33], v13 offset:53248
  ds_read_b64_tr_b16 v[34:35], v13 offset:53760
  ds_read_b64_tr_b16 v[36:37], v13 offset:55296
  ds_read_b64_tr_b16 v[38:39], v13 offset:55808
  v_mfma_f32_32x32x16_bf16 v[96:111], v[40:43], v[48:51], v[96:111]
  s_waitcnt lgkmcnt(10)
  s_mov_b64 exec, 1
  ds_add_u32 v2, v3 offset:64
  s_mov_b64 exec, -1
  v_mfma_f32_32x32x16_bf16 v[80:95], v[116:119], v[112:115], v[80:95]
  ds_read_b128 v[40:43], v10 offset:24576
  ds_read_b64_tr_b16 v[44:45], v13 offset:57344
  ds_read_b64_tr_b16 v[46:47], v13 offset:57856
  ds_read_b64_tr_b16 v[48:49], v13 offset:59392
  ds_read_b64_tr_b16 v[50:51], v13 offset:59904
  v_mfma_f32_32x32x16_bf16 v[96:111], v[112:115], v[120:123], v[96:111]
  s_waitcnt lgkmcnt(10)
  v_mfma_f32_32x32x16_bf16 v[80:95], v[20:23], v[16:19], v[80:95]
  ds_read_b128 v[112:115], v11 offset:24576
  ds_read_b64_tr_b16 v[116:117], v13 offset:61440
  ds_read_b64_tr_b16 v[118:119], v13 offset:61952
  ds_read_b64_tr_b16 v[120:121], v13 offset:63488
  ds_read_b64_tr_b16 v[122:123], v13 offset:64000
  v_mfma_f32_32x32x16_bf16 v[96:111], v[16:19], v[24:27], v[96:111]
  s_waitcnt lgkmcnt(10)
  v_readfirstlane_b32 s68, v60
  s_nop 0
  s_cmp_ge_u32 s68, 4
  s_cbranch_scc1 Lok31
  s_mov_b32 s70, 0x400000
Lsp30:
  ds_read_b32 v60, v2 offset:16
  s_sub_u32 s70, s70, 1
  s_cbranch_scc1 Lok31
  s_waitcnt lgkmcnt(0)
  v_readfirstlane_b32 s68, v60
  s_nop 0
  s_cmp_lt_u32 s68, 4
  s_cbranch_scc1 Lsp30
Lok31:
  v_mfma_f32_32x32x16_bf16 v[80:95], v[32:35], v[28:31], v[80:95]
  ds_read_b128 v[16:19], v8 offset:32768
  ds_read_b64_tr_b16 v[20:21], v13 offset:0
  ds_read_b64_tr_b16 v[22:23], v13 offset:512
  ds_read_b64_tr_b16 v[24:25], v13 offset:2048
  ds_read_b64_tr_b16 v[26:27], v13 offset:2560
  v_mfma_f32_32x32x16_bf16 v[96:111], v[28:31], v[36:39], v[96:111]
  s_waitcnt lgkmcnt(10)
  v_mfma_f32_32x32x16_bf16 v[80:95], v[44:47], v[40:43], v[80:95]
  ds_read_b32 v60, v2 offset:20
  ds_read_b128 v[28:31], v9 offset:32768
  ds_read_b64_tr_b16 v[32:33], v13 offset:4096
  ds_read_b64_tr_b16 v[34:35], v13 offset:4608
  ds_read_b64_tr_b16 v[36:37], v13 offset:6144
  ds_read_b64_tr_b16 v[38:39], v13 offset:6656
  v_mfma_f32_32x32x16_bf16 v[96:111], v[40:43], v[48:51], v[96:111]
  s_waitcnt lgkmcnt(10)
  s_mov_b64 exec, 1
  ds_add_u32 v2, v3 offset:68
  s_mov_b64 exec, -1
  v_mfma_f32_32x32x16_bf16 v[80:95], v[116:119], v[112:115], v[80:95]
  ds_read_b128 v[40:43], v10 offset:32768
  ds_read_b64_tr_b16 v[44:45], v13 offset:8192
  ds_read_b64_tr_b16 v[46:47], v13 offset:8704
  ds_read_b64_tr_b16 v[48:49], v13 offset:10240
  ds_read_b64_tr_b16 v[50:51], v13 offset:10752
  v_mfma_f32_32x32x16_bf16 v[96:111], v[112:115], v[120:123], v[96:111]
  s_waitcnt lgkmcnt(10)
  v_mfma_f32_32x32x16_bf16 v[80:95], v[20:23], v[16:19], v[80:95]
  ds_read_b128 v[112:115], v11 offset:32768
  ds_read_b64_tr_b16 v[116:117], v13 offset:12288
  ds_read_b64_tr_b16 v[118:119], v13 offset:12800
  ds_read_b64_tr_b16 v[120:121], v13 offset:14336
  ds_read_b64_tr_b16 v[122:123], v13 offset:14848
  v_mfma_f32_32x32x16_bf16 v[96:111], v[16:19], v[24:27], v[96:111]
  s_waitcnt lgkmcnt(10)
  v_readfirstlane_b32 s68, v60
  s_nop 0
  s_cmp_ge_u32 s68, 4
  s_cbranch_scc1 Lok33
  s_mov_b32 s70, 0x400000
Lsp32:
  ds_read_b32 v60, v2 offset:20
  s_sub_u32 s70, s70, 1
  s_cbranch_scc1 Lok33
  s_waitcnt lgkmcnt(0)
  v_readfirstlane_b32 s68, v60
  s_nop 0
  s_cmp_lt_u32 s68, 4
  s_cbranch_scc1 Lsp32
Lok33:
  v_mfma_f32_32x32x16_bf16 v[80:95], v[32:35], v[28:31], v[80:95]
  ds_read_b128 v[16:19], v8 offset:40960
  ds_read_b64_tr_b16 v[20:21], v13 offset:16384
  ds_read_b64_tr_b16 v[22:23], v13 offset:16896
  ds_read_b64_tr_b16 v[24:25], v13 offset:18432
  ds_read_b64_tr_b16 v[26:27], v13 offset:18944
  v_mfma_f32_32x32x16_bf16 v[96:111], v[28:31], v[36:39], v[96:111]
  s_waitcnt lgkmcnt(10)
  v_mfma_f32_32x32x16_bf16 v[80:95], v[44:47], v[40:43], v[80:95]
  ds_read_b32 v60, v2 offset:24
  ds_read_b128 v[28:31], v9 offset:40960
  ds_read_b64_tr_b16 v[32:33], v13 offset:20480
  ds_read_b64_tr_b16 v[34:35], v13 offset:20992
  ds_read_b64_tr_b16 v[36:37], v13 offset:22528
  ds_read_b64_tr_b16 v[38:39], v13 offset:23040
  v_mfma_f32_32x32x16_bf16 v[96:111], v[40:43], v[48:51], v[96:111]
  s_waitcnt lgkmcnt(10)
  s_mov_b64 exec, 1
  ds_add_u32 v2, v3 offset:72
  s_mov_b64 exec, -1
  v_mfma_f32_32x32x16_bf16 v[80:95], v[116:119], v[112:115], v[80:95]
  ds_read_b128 v[40:43], v10 offset:40960
  ds_read_b64_tr_b16 v[44:45], v13 offset:24576
  ds_read_b64_tr_b16 v[46:47], v13 offset:25088
  ds_read_b64_tr_b16 v[48:49], v13 offset:26624
  ds_read_b64_tr_b16 v[50:51], v13 offset:27136
  v_mfma_f32_32x32x16_bf16 v[96:111], v[112:115], v[120:123], v[96:111]
  s_waitcnt lgkmcnt(10)
  v_mfma_f32_32x32x16_bf16 v[80:95], v[20:23], v[16:19], v[80:95]
  ds_read_b128 v[112:115], v11 offset:40960
  ds_read_b64_tr_b16 v[116:117], v13 offset:28672
  ds_read_b64_tr_b16 v[118:119], v13 offset:29184
  ds_read_b64_tr_b16 v[120:121], v13 offset:30720
  ds_read_b64_tr_b16 v[122:123], v13 offset:31232
  v_mfma_f32_32x32x16_bf16 v[96:111], v[16:19], v[24:27], v[96:111]
  s_waitcnt lgkmcnt(10)
  v_readfirstlane_b32 s68, v60
  s_nop 0
  s_cmp_ge_u32 s68, 4
  s_cbranch_scc1 Lok35
  s_mov_b32 s70, 0x400000
Lsp34:
  ds_read_b32 v60, v2 offset:24
  s_sub_u32 s70, s70, 1
  s_cbranch_scc1 Lok35
  s_waitcnt lgkmcnt(0)
  v_readfirstlane_b32 s68, v60
  s_nop 0
  s_cmp_lt_u32 s68, 4
  s_cbranch_scc1 Lsp34
Lok35:
  v_mfma_f32_32x32x16_bf16 v[80:95], v[32:35], v[28:31], v[80:95]
  ds_read_b128 v[16:19], v8 offset:49152
  ds_read_b64_tr_b16 v[20:21], v13 offset:32768
  ds_read_b64_tr_b16 v[22:23], v13 offset:33280
  ds_read_b64_tr_b16 v[24:25], v13 offset:34816
  ds_read_b64_tr_b16 v[26:27], v13 offset:35328
  v_mfma_f32_32x32x16_bf16 v[96:111], v[28:31], v[36:39], v[96:111]
  s_waitcnt lgkmcnt(10)
  v_mfma_f32_32x32x16_bf16 v[80:95], v[44:47], v[40:43], v[80:95]
  ds_read_b32 v60, v2 offset:28
  ds_read_b128 v[28:31], v9 offset:49152
  ds_read_b64_tr_b16 v[32:33], v13 offset:36864
  ds_read_b64_tr_b16 v[34:35], v13 offset:37376
  ds_read_b64_tr_b16 v[36:37], v13 offset:38912
  ds_read_b64_tr_b16 v[38:39], v13 offset:39424
  v_mfma_f32_32x32x16_bf16 v[96:111], v[40:43], v[48:51], v[96:111]
  s_waitcnt lgkmcnt(10)
  s_mov_b64 exec, 1
  ds_add_u32 v2, v3 offset:76
  s_mov_b64 exec, -1
  v_mfma_f32_32x32x16_bf16 v[80:95], v[116:119], v[112:115], v[80:95]
  ds_read_b128 v[40:43], v10 offset:49152
  ds_read_b64_tr_b16 v[44:45], v13 offset:40960
  ds_read_b64_tr_b16 v[46:47], v13 offset:41472
  ds_read_b64_tr_b16 v[48:49], v13 offset:43008
  ds_read_b64_tr_b16 v[50:51], v13 offset:43520
  v_mfma_f32_32x32x16_bf16 v[96:111], v[112:115], v[120:123], v[96:111]
  s_waitcnt lgkmcnt(10)
  v_mfma_f32_32x32x16_bf16 v[80:95], v[20:23], v[16:19], v[80:95]
  ds_read_b128 v[112:115], v11 offset:49152
  ds_read_b64_tr_b16 v[116:117], v13 offset:45056
  ds_read_b64_tr_b16 v[118:119], v13 offset:45568
  ds_read_b64_tr_b16 v[120:121], v13 offset:47104
  ds_read_b64_tr_b16 v[122:123], v13 offset:47616
  v_mfma_f32_32x32x16_bf16 v[96:111], v[16:19], v[24:27], v[96:111]
  s_waitcnt lgkmcnt(10)
  v_readfirstlane_b32 s68, v60
  s_nop 0
  s_cmp_ge_u32 s68, 4
  s_cbranch_scc1 Lok37
  s_mov_b32 s70, 0x400000
Lsp36:
  ds_read_b32 v60, v2 offset:28
  s_sub_u32 s70, s70, 1
  s_cbranch_scc1 Lok37
  s_waitcnt lgkmcnt(0)
  v_readfirstlane_b32 s68, v60
  s_nop 0
  s_cmp_lt_u32 s68, 4
  s_cbranch_scc1 Lsp36
Lok37:
  v_mfma_f32_32x32x16_bf16 v[80:95], v[32:35], v[28:31], v[80:95]
  ds_read_b128 v[16:19], v8 offset:57344
  ds_read_b64_tr_b16 v[20:21], v13 offset:49152
  ds_read_b64_tr_b16 v[22:23], v13 offset:49664
  ds_read_b64_tr_b16 v[24:25], v13 offset:51200
  ds_read_b64_tr_b16 v[26:27], v13 offset:51712
  v_mfma_f32_32x32x16_bf16 v[96:111], v[28:31], v[36:39], v[96:111]
  s_waitcnt lgkmcnt(10)
  v_mfma_f32_32x32x16_bf16 v[80:95], v[44:47], v[40:43], v[80:95]
  ds_read_b128 v[28:31], v9 offset:57344
  ds_read_b64_tr_b16 v[32:33], v13 offset:53248
  ds_read_b64_tr_b16 v[34:35], v13 offset:53760
  ds_read_b64_tr_b16 v[36:37], v13 offset:55296
  ds_read_b64_tr_b16 v[38:39], v13 offset:55808
  v_mfma_f32_32x32x16_bf16 v[96:111], v[40:43], v[48:51], v[96:111]
  s_waitcnt lgkmcnt(10)
  s_mov_b64 exec, 1
  ds_add_u32 v2, v3 offset:80
  s_mov_b64 exec, -1
  v_mfma_f32_32x32x16_bf16 v[80:95], v[116:119], v[112:115], v[80:95]
  ds_read_b128 v[40:43], v10 offset:57344
  ds_read_b64_tr_b16 v[44:45], v13 offset:57344
  ds_read_b64_tr_b16 v[46:47], v13 offset:57856
  ds_read_b64_tr_b16 v[48:49], v13 offset:59392
  ds_read_b64_tr_b16 v[50:51], v13 offset:59904
  v_mfma_f32_32x32x16_bf16 v[96:111], v[112:115], v[120:123], v[96:111]
  s_waitcnt lgkmcnt(10)
  v_mfma_f32_32x32x16_bf16 v[80:95], v[20:23], v[16:19], v[80:95]
  ds_read_b128 v[112:115], v11 offset:57344
  ds_read_b64_tr_b16 v[116:117], v13 offset:61440
  ds_read_b64_tr_b16 v[118:119], v13 offset:61952
  ds_read_b64_tr_b16 v[120:121], v13 offset:63488
  ds_read_b64_tr_b16 v[122:123], v13 offset:64000
  v_mfma_f32_32x32x16_bf16 v[96:111], v[16:19], v[24:27], v[96:111]
  s_waitcnt lgkmcnt(10)
  v_mfma_f32_32x32x16_bf16 v[80:95], v[32:35], v[28:31], v[80:95]
  v_mfma_f32_32x32x16_bf16 v[96:111], v[28:31], v[36:39], v[96:111]
  s_waitcnt lgkmcnt(5)
  v_mfma_f32_32x32x16_bf16 v[80:95], v[44:47], v[40:43], v[80:95]
  v_mfma_f32_32x32x16_bf16 v[96:111], v[40:43], v[48:51], v[96:111]
  s_waitcnt lgkmcnt(0)
  s_mov_b64 exec, 1
  ds_add_u32 v2, v3 offset:84
  s_mov_b64 exec, -1
  v_mfma_f32_32x32x16_bf16 v[80:95], v[116:119], v[112:115], v[80:95]
  v_mfma_f32_32x32x16_bf16 v[96:111], v[112:115], v[120:123], v[96:111]
  s_mov_b32 s58, 0
  s_nop 9
  v_cvt_pk_bf16_f32 v32, v80, v81
  v_cvt_pk_bf16_f32 v33, v82, v83
  v_cvt_pk_bf16_f32 v34, v84, v85
  v_cvt_pk_bf16_f32 v35, v86, v87
  v_cvt_pk_bf16_f32 v36, v88, v89
  v_cvt_pk_bf16_f32 v37, v90, v91
  v_cvt_pk_bf16_f32 v38, v92, v93
  v_cvt_pk_bf16_f32 v39, v94, v95
  buffer_store_dwordx4 v[32:35], v52, s[36:39], s64 offen sc1
  buffer_store_dwordx4 v[36:39], v52, s[36:39], s65 offen sc1
  ds_read_b32 v60, v2 offset:32
  ds_read_b32 v61, v2 offset:120
  v_cvt_pk_bf16_f32 v40, v96, v97
  v_cvt_pk_bf16_f32 v41, v98, v99
  v_cvt_pk_bf16_f32 v42, v100, v101
  v_cvt_pk_bf16_f32 v43, v102, v103
  v_cvt_pk_bf16_f32 v44, v104, v105
  v_cvt_pk_bf16_f32 v45, v106, v107
  v_cvt_pk_bf16_f32 v46, v108, v109
  v_cvt_pk_bf16_f32 v47, v110, v111
  buffer_store_dwordx4 v[40:43], v53, s[36:39], s66 offen sc1
  buffer_store_dwordx4 v[44:47], v53, s[36:39], s66 offen offset:512 sc1
  s_waitcnt lgkmcnt(0)
  v_readfirstlane_b32 s68, v61
  s_nop 0
  s_cmp_ge_u32 s68, 4
  s_cbranch_scc1 Lok39
  s_mov_b32 s70, 0x400000
Lsp38:
  s_sleep 1
  ds_read_b32 v61, v2 offset:120
  s_sub_u32 s70, s70, 1
  s_cbranch_scc1 Lok39
  s_waitcnt lgkmcnt(0)
  v_readfirstlane_b32 s68, v61
  s_nop 0
  s_cmp_lt_u32 s68, 4
  s_cbranch_scc1 Lsp38
Lok39:
  v_readfirstlane_b32 s68, v60
  s_nop 0
  s_cmp_ge_u32 s68, 4
  s_cbranch_scc1 Lok41
  s_cmp_lg_u32 s58, 0
  s_cbranch_scc1 Lgp42
  s_waitcnt vmcnt(0)
  s_mov_b64 exec, 1
  ds_add_rtn_u32 v162, v2, v3 offset:124
  v_mov_b32 v164, s34
  v_mov_b32 v165, s35
  v_mov_b32 v163, 0
  s_waitcnt lgkmcnt(0)
  v_readfirstlane_b32 s68, v162
  s_nop 0
  s_cmp_lg_u32 s68, 3
  s_cbranch_scc1 Lpb43
  buffer_store_dwordx2 v[164:165], v163, s[36:39], s49 offen sc1
Lpb43:
  s_mov_b64 exec, -1
  s_mov_b32 s58, 1
Lgp42:
  s_mov_b32 s70, 0x400000
Lsp40:
  ds_read_b32 v60, v2 offset:32
  s_sub_u32 s70, s70, 1
  s_cbranch_scc1 Lok41
  s_waitcnt lgkmcnt(0)
  v_readfirstlane_b32 s68, v60
  s_nop 0
  s_cmp_lt_u32 s68, 4
  s_cbranch_scc1 Lsp40
Lok41:
  ds_read_b32 v60, v2 offset:36
  ds_read_b128 v[80:83], v8 offset:0
  ds_read_b64_tr_b16 v[84:85], v13 offset:0
  ds_read_b64_tr_b16 v[86:87], v13 offset:512
  ds_read_b128 v[88:91], v9 offset:0
  ds_read_b64_tr_b16 v[92:93], v13 offset:2048
  ds_read_b64_tr_b16 v[94:95], v13 offset:2560
  ds_read_b128 v[96:99], v10 offset:0
  ds_read_b64_tr_b16 v[100:101], v13 offset:4096
  ds_read_b64_tr_b16 v[102:103], v13 offset:4608
  ds_read_b128 v[104:107], v11 offset:0
  ds_read_b64_tr_b16 v[108:109], v13 offset:6144
  ds_read_b64_tr_b16 v[110:111], v13 offset:6656
  ds_read_b128 v[112:115], v8 offset:8192
  ds_read_b64_tr_b16 v[116:117], v13 offset:8192
  ds_read_b64_tr_b16 v[118:119], v13 offset:8704
  s_waitcnt lgkmcnt(12)
  v_mfma_f32_32x32x16_bf16 v[64:79], v[84:87], v[80:83], 0
  ds_read_b128 v[120:123], v9 offset:8192
  ds_read_b64_tr_b16 v[124:125], v13 offset:10240
  ds_read_b64_tr_b16 v[126:127], v13 offset:10752
  s_waitcnt lgkmcnt(12)
  v_mfma_f32_32x32x16_bf16 v[64:79], v[92:95], v[88:91], v[64:79]
  ds_read_b128 v[16:19], v10 offset:8192
  ds_read_b64_tr_b16 v[20:21], v13 offset:12288
  ds_read_b64_tr_b16 v[22:23], v13 offset:12800
  s_waitcnt lgkmcnt(12)
  v_mfma_f32_32x32x16_bf16 v[64:79], v[100:103], v[96:99], v[64:79]
  ds_read_b128 v[24:27], v11 offset:8192
  ds_read_b64_tr_b16 v[28:29], v13 offset:14336
  ds_read_b64_tr_b16 v[30:31], v13 offset:14848
  s_waitcnt lgkmcnt(12)
  v_readfirstlane_b32 s68, v60
  s_nop 0
  s_cmp_ge_u32 s68, 4
  s_cbranch_scc1 Lok45
  s_cmp_lg_u32 s58, 0
  s_cbranch_scc1 Lgp46
  s_waitcnt vmcnt(0)
  s_mov_b64 exec, 1
  ds_add_rtn_u32 v162, v2, v3 offset:124
  v_mov_b32 v164, s34
  v_mov_b32 v165, s35
  v_mov_b32 v163, 0
  s_waitcnt lgkmcnt(0)
  v_readfirstlane_b32 s68, v162
  s_nop 0
  s_cmp_lg_u32 s68, 3
  s_cbranch_scc1 Lpb47
  buffer_store_dwordx2 v[164:165], v163, s[36:39], s49 offen sc1
Lpb47:
  s_mov_b64 exec, -1
  s_mov_b32 s58, 1
Lgp46:
  s_mov_b32 s70, 0x400000
Lsp44:
  ds_read_b32 v60, v2 offset:36
  s_sub_u32 s70, s70, 1
  s_cbranch_scc1 Lok45
  s_waitcnt lgkmcnt(0)
  v_readfirstlane_b32 s68, v60
  s_nop 0
  s_cmp_lt_u32 s68, 4
  s_cbranch_scc1 Lsp44
Lok45:
  v_mfma_f32_32x32x16_bf16 v[64:79], v[108:111], v[104:107], v[64:79]
  ds_read_b128 v[80:83], v8 offset:16384
  ds_read_b64_tr_b16 v[84:85], v13 offset:16384
  ds_read_b64_tr_b16 v[86:87], v13 offset:16896
  s_waitcnt lgkmcnt(12)
  v_mfma_f32_32x32x16_bf16 v[64:79], v[116:119], v[112:115], v[64:79]
  ds_read_b128 v[88:91], v9 offset:16384
  ds_read_b64_tr_b16 v[92:93], v13 offset:18432
  ds_read_b64_tr_b16 v[94:95], v13 offset:18944
  s_waitcnt lgkmcnt(12)
  v_mfma_f32_32x32x16_bf16 v[64:79], v[124:127], v[120:123], v[64:79]
  ds_read_b128 v[96:99], v10 offset:16384
  ds_read_b64_tr_b16 v[100:101], v13 offset:20480
  ds_read_b64_tr_b16 v[102:103], v13 offset:20992
  s_waitcnt lgkmcnt(12)
  v_mfma_f32_32x32x16_bf16 v[64:79], v[20:23], v[16:19], v[64:79]
  ds_read_b32 v60, v2 offset:40
  ds_read_b128 v[104:107], v11 offset:16384
  ds_read_b64_tr_b16 v[108:109], v13 offset:22528
  ds_read_b64_tr_b16 v[110:111], v13 offset:23040
  s_waitcnt lgkmcnt(12)
  s_mov_b64 exec, 1
  ds_add_u32 v2, v3 offset:88
  s_mov_b64 exec, -1
  v_mfma_f32_32x32x16_bf16 v[64:79], v[28:31], v[24:27], v[64:79]
  ds_read_b128 v[112:115], v8 offset:24576
  ds_read_b64_tr_b16 v[116:117], v13 offset:24576
  ds_read_b64_tr_b16 v[118:119], v13 offset:25088
  s_waitcnt lgkmcnt(12)
  v_mfma_f32_32x32x16_bf16 v[64:79], v[84:87], v[80:83], v[64:79]
  ds_read_b128 v[120:123], v9 offset:24576
  ds_read_b64_tr_b16 v[124:125], v13 offset:26624
  ds_read_b64_tr_b16 v[126:127], v13 offset:27136
  s_waitcnt lgkmcnt(12)
  v_mfma_f32_32x32x16_bf16 v[64:79], v[92:95], v[88:91], v[64:79]
  ds_read_b128 v[16:19], v10 offset:24576
  ds_read_b64_tr_b16 v[20:21], v13 offset:28672
  ds_read_b64_tr_b16 v[22:23], v13 offset:29184
  s_waitcnt lgkmcnt(12)
  v_mfma_f32_32x32x16_bf16 v[64:79], v[100:103], v[96:99], v[64:79]
  ds_read_b128 v[24:27], v11 offset:24576
  ds_read_b64_tr_b16 v[28:29], v13 offset:30720
  ds_read_b64_tr_b16 v[30:31], v13 offset:31232
  s_waitcnt lgkmcnt(12)
  v_readfirstlane_b32 s68, v60
  s_nop 0
  s_cmp_ge_u32 s68, 4
  s_cbranch_scc1 Lok49
  s_cmp_lg_u32 s58, 0
  s_cbranch_scc1 Lgp50
  s_waitcnt vmcnt(0)
  s_mov_b64 exec, 1
  ds_add_rtn_u32 v162, v2, v3 offset:124
  v_mov_b32 v164, s34
  v_mov_b32 v165, s35
  v_mov_b32 v163, 0
  s_waitcnt lgkmcnt(0)
  v_readfirstlane_b32 s68, v162
  s_nop 0
  s_cmp_lg_u32 s68, 3
  s_cbranch_scc1 Lpb51
  buffer_store_dwordx2 v[164:165], v163, s[36:39], s49 offen sc1
Lpb51:
  s_mov_b64 exec, -1
  s_mov_b32 s58, 1
Lgp50:
  s_mov_b32 s70, 0x400000
Lsp48:
  ds_read_b32 v60, v2 offset:40
  s_sub_u32 s70, s70, 1
  s_cbranch_scc1 Lok49
  s_waitcnt lgkmcnt(0)
  v_readfirstlane_b32 s68, v60
  s_nop 0
  s_cmp_lt_u32 s68, 4
  s_cbranch_scc1 Lsp48
Lok49:
  v_mfma_f32_32x32x16_bf16 v[64:79], v[108:111], v[104:107], v[64:79]
  ds_read_b128 v[80:83], v8 offset:32768
  ds_read_b64_tr_b16 v[84:85], v13 offset:32768
  ds_read_b64_tr_b16 v[86:87], v13 offset:33280
  s_waitcnt lgkmcnt(12)
  v_mfma_f32_32x32x16_bf16 v[64:79], v[116:119], v[112:115], v[64:79]
  ds_read_b128 v[88:91], v9 offset:32768
  ds_read_b64_tr_b16 v[92:93], v13 offset:34816
  ds_read_b64_tr_b16 v[94:95], v13 offset:35328
  s_waitcnt lgkmcnt(12)
  v_mfma_f32_32x32x16_bf16 v[64:79], v[124:127], v[120:123], v[64:79]
  ds_read_b128 v[96:99], v10 offset:32768
  ds_read_b64_tr_b16 v[100:101], v13 offset:36864
  ds_read_b64_tr_b16 v[102:103], v13 offset:37376
  s_waitcnt lgkmcnt(12)
  v_mfma_f32_32x32x16_bf16 v[64:79], v[20:23], v[16:19], v[64:79]
  ds_read_b32 v60, v2 offset:44
  ds_read_b128 v[104:107], v11 offset:32768
  ds_read_b64_tr_b16 v[108:109], v13 offset:38912
  ds_read_b64_tr_b16 v[110:111], v13 offset:39424
  s_waitcnt lgkmcnt(12)
  s_cmp_lg_u32 s58, 0
  s_cbranch_scc1 Lgp52
  s_waitcnt vmcnt(0)
  s_mov_b64 exec, 1
  ds_add_rtn_u32 v162, v2, v3 offset:124
  v_mov_b32 v164, s34
  v_mov_b32 v165, s35
  v_mov_b32 v163, 0
  s_waitcnt lgkmcnt(0)
  v_readfirstlane_b32 s68, v162
  s_nop 0
  s_cmp_lg_u32 s68, 3
  s_cbranch_scc1 Lpb53
  buffer_store_dwordx2 v[164:165], v163, s[36:39], s49 offen sc1
Lpb53:
  s_mov_b64 exec, -1
  s_mov_b32 s58, 1
Lgp52:
  v_mfma_f32_32x32x16_bf16 v[64:79], v[28:31], v[24:27], v[64:79]
  ds_read_b128 v[112:115], v8 offset:40960
  ds_read_b64_tr_b16 v[116:117], v13 offset:40960
  ds_read_b64_tr_b16 v[118:119], v13 offset:41472
  s_waitcnt lgkmcnt(12)
  v_mfma_f32_32x32x16_bf16 v[64:79], v[84:87], v[80:83], v[64:79]
  ds_read_b128 v[120:123], v9 offset:40960
  ds_read_b64_tr_b16 v[124:125], v13 offset:43008
  ds_read_b64_tr_b16 v[126:127], v13 offset:43520
  s_waitcnt lgkmcnt(12)
  v_mfma_f32_32x32x16_bf16 v[64:79], v[92:95], v[88:91], v[64:79]
  ds_read_b128 v[16:19], v10 offset:40960
  ds_read_b64_tr_b16 v[20:21], v13 offset:45056
  ds_read_b64_tr_b16 v[22:23], v13 offset:45568
  s_waitcnt lgkmcnt(12)
  v_mfma_f32_32x32x16_bf16 v[64:79], v[100:103], v[96:99], v[64:79]
  ds_read_b128 v[24:27], v11 offset:40960
  ds_read_b64_tr_b16 v[28:29], v13 offset:47104
  ds_read_b64_tr_b16 v[30:31], v13 offset:47616
  s_waitcnt lgkmcnt(12)
  v_readfirstlane_b32 s68, v60
  s_nop 0
  s_cmp_ge_u32 s68, 4
  s_cbranch_scc1 Lok55
  s_cmp_lg_u32 s58, 0
  s_cbranch_scc1 Lgp56
  s_waitcnt vmcnt(0)
  s_mov_b64 exec, 1
  ds_add_rtn_u32 v162, v2, v3 offset:124
  v_mov_b32 v164, s34
  v_mov_b32 v165, s35
  v_mov_b32 v163, 0
  s_waitcnt lgkmcnt(0)
  v_readfirstlane_b32 s68, v162
  s_nop 0
  s_cmp_lg_u32 s68, 3
  s_cbranch_scc1 Lpb57
  buffer_store_dwordx2 v[164:165], v163, s[36:39], s49 offen sc1
Lpb57:
  s_mov_b64 exec, -1
  s_mov_b32 s58, 1
Lgp56:
  s_mov_b32 s70, 0x400000
Lsp54:
  ds_read_b32 v60, v2 offset:44
  s_sub_u32 s70, s70, 1
  s_cbranch_scc1 Lok55
  s_waitcnt lgkmcnt(0)
  v_readfirstlane_b32 s68, v60
  s_nop 0
  s_cmp_lt_u32 s68, 4
  s_cbranch_scc1 Lsp54
Lok55:
  v_mfma_f32_32x32x16_bf16 v[64:79], v[108:111], v[104:107], v[64:79]
  ds_read_b128 v[80:83], v8 offset:49152
  ds_read_b64_tr_b16 v[84:85], v13 offset:49152
  ds_read_b64_tr_b16 v[86:87], v13 offset:49664
  s_waitcnt lgkmcnt(12)
  v_mfma_f32_32x32x16_bf16 v[64:79], v[116:119], v[112:115], v[64:79]
  ds_read_b128 v[88:91], v9 offset:49152
  ds_read_b64_tr_b16 v[92:93], v13 offset:51200
  ds_read_b64_tr_b16 v[94:95], v13 offset:51712
  s_waitcnt lgkmcnt(12)
  v_mfma_f32_32x32x16_bf16 v[64:79], v[124:127], v[120:123], v[64:79]
  ds_read_b128 v[96:99], v10 offset:49152
  ds_read_b64_tr_b16 v[100:101], v13 offset:53248
  ds_read_b64_tr_b16 v[102:103], v13 offset:53760
  s_waitcnt lgkmcnt(12)
  v_mfma_f32_32x32x16_bf16 v[64:79], v[20:23], v[16:19], v[64:79]
  ds_read_b128 v[104:107], v11 offset:49152
  ds_read_b64_tr_b16 v[108:109], v13 offset:55296
  ds_read_b64_tr_b16 v[110:111], v13 offset:55808
  s_waitcnt lgkmcnt(12)
  v_mfma_f32_32x32x16_bf16 v[64:79], v[28:31], v[24:27], v[64:79]
  ds_read_b128 v[112:115], v8 offset:57344
  ds_read_b64_tr_b16 v[116:117], v13 offset:57344
  ds_read_b64_tr_b16 v[118:119], v13 offset:57856
  s_waitcnt lgkmcnt(12)
  v_mfma_f32_32x32x16_bf16 v[64:79], v[84:87], v[80:83], v[64:79]
  ds_read_b128 v[120:123], v9 offset:57344
  ds_read_b64_tr_b16 v[124:125], v13 offset:59392
  ds_read_b64_tr_b16 v[126:127], v13 offset:59904
  s_waitcnt lgkmcnt(12)
  v_mfma_f32_32x32x16_bf16 v[64:79], v[92:95], v[88:91], v[64:79]
  ds_read_b128 v[16:19], v10 offset:57344
  ds_read_b64_tr_b16 v[20:21], v13 offset:61440
  ds_read_b64_tr_b16 v[22:23], v13 offset:61952
  s_waitcnt lgkmcnt(12)
  v_mfma_f32_32x32x16_bf16 v[64:79], v[100:103], v[96:99], v[64:79]
  ds_read_b32 v61, v2 offset:88
  ds_read_b128 v[24:27], v11 offset:57344
  ds_read_b64_tr_b16 v[28:29], v13 offset:63488
  ds_read_b64_tr_b16 v[30:31], v13 offset:64000
  s_waitcnt lgkmcnt(12)
  v_mfma_f32_32x32x16_bf16 v[64:79], v[108:111], v[104:107], v[64:79]
  s_waitcnt lgkmcnt(9)
  v_mfma_f32_32x32x16_bf16 v[64:79], v[116:119], v[112:115], v[64:79]
  s_waitcnt lgkmcnt(6)
  v_mfma_f32_32x32x16_bf16 v[64:79], v[124:127], v[120:123], v[64:79]
  s_waitcnt lgkmcnt(3)
  v_mfma_f32_32x32x16_bf16 v[64:79], v[20:23], v[16:19], v[64:79]
  s_waitcnt lgkmcnt(0)
  s_mov_b64 exec, 1
  ds_add_u32 v2, v3 offset:136
  s_mov_b64 exec, -1
  v_mfma_f32_32x32x16_bf16 v[64:79], v[28:31], v[24:27], v[64:79]
  v_readfirstlane_b32 s68, v61
  s_nop 0
  s_cmp_ge_u32 s68, 4
  s_cbranch_scc1 Lok59
  s_mov_b32 s70, 0x400000
Lsp58:
  s_sleep 1
  ds_read_b32 v61, v2 offset:88
  s_sub_u32 s70, s70, 1
  s_cbranch_scc1 Lok59
  s_waitcnt lgkmcnt(0)
  v_readfirstlane_b32 s68, v61
  s_nop 0
  s_cmp_lt_u32 s68, 4
  s_cbranch_scc1 Lsp58
Lok59:
  ds_write_b128 v54, v[32:35] offset:8192
  ds_write_b128 v54, v[36:39] offset:10240
  s_nop 5
  v_mul_f32 v64, s67, v64
  v_mul_f32 v65, s67, v65
  v_mul_f32 v66, s67, v66
  v_mul_f32 v67, s67, v67
  v_mul_f32 v68, s67, v68
  v_mul_f32 v69, s67, v69
  v_mul_f32 v70, s67, v70
  v_mul_f32 v71, s67, v71
  v_cvt_pk_bf16_f32 v16, v64, v65
  v_cvt_pk_bf16_f32 v17, v66, v67
  v_cvt_pk_bf16_f32 v18, v68, v69
  v_cvt_pk_bf16_f32 v19, v70, v71
  ds_write_b128 v54, v[16:19] offset:0
  v_mul_f32 v72, s67, v72
  v_mul_f32 v73, s67, v73
  v_mul_f32 v74, s67, v74
  v_mul_f32 v75, s67, v75
  v_mul_f32 v76, s67, v76
  v_mul_f32 v77, s67, v77
  v_mul_f32 v78, s67, v78
  v_mul_f32 v79, s67, v79
  v_cvt_pk_bf16_f32 v20, v72, v73
  v_cvt_pk_bf16_f32 v21, v74, v75
  v_cvt_pk_bf16_f32 v22, v76, v77
  v_cvt_pk_bf16_f32 v23, v78, v79
  ds_write_b128 v54, v[20:23] offset:2048
  s_mov_b64 exec, 1
  ds_add_u32 v2, v3 offset:144
  s_mov_b64 exec, -1
  s_branch L_attn2
L_X:
  s_setprio 3
  s_sub_u32 s51, s3, 4
  s_lshr_b32 s50, s51, 1
  s_lshl_b32 s53, s2, 1
  s_add_u32 s52, s50, s53
  s_and_b32 s53, s51, 1
  s_mul_i32 s54, s51, 4160
  s_add_u32 s54, s54, 131072
  s_lshl_b32 s55, s52, 8
  s_lshl_b32 s56, s53, 7
  s_add_u32 s55, s55, s56
  v_lshl_add_u32 v7, v1, 1, s55
  s_lshl_b32 s56, s52, 1
  v_mov_b32 v4, s56
  v_lshrrev_b32 v5, 1, v1
  v_lshlrev_b32 v5, 10, v5
  v_and_b32 v6, 1, v1
  v_lshl_add_u32 v5, v6, 4, v5
  s_lshr_b32 s57, s2, 3
  s_and_b32 s58, s2, 7
  s_lshl_b32 s58, s58, 2
  s_add_u32 s58, s58, s51
  s_lshl_b32 s59, s57, 16
  s_lshl_b32 s60, s58, 5
  s_add_u32 s59, s59, s60
  s_add_u32 s60, s59, 32768
  s_lshr_b32 s95, s2, 5
  s_lshl_b32 s95, s95, 2
  s_and_b32 s96, s2, 3
  s_add_u32 s95, s95, s96
  s_and_b32 s96, s2, 4
  s_bfe_u32 s68, s2, 0x20003
  s_add_u32 s96, s96, s68
  s_waitcnt lgkmcnt(0)
  global_load_ushort v14, v4, s[24:25]
  global_load_ushort v8, v7, s[12:13]
  global_load_ushort v9, v7, s[14:15]
  global_load_ushort v10, v7, s[16:17]
  global_load_ushort v11, v7, s[18:19]
  global_load_ushort v12, v7, s[20:21]
  global_load_ushort v13, v7, s[22:23]
  s_mov_b32 s44, s10
  s_mov_b32 s45, s11
  s_mov_b32 s46, 2097152
  s_mov_b32 s47, 0x20000
  s_mov_b32 m0, s54
  s_nop 0
  buffer_load_dwordx4 v5, s[44:47], s59 offen lds
  s_add_u32 m0, s54, 1024
  s_nop 0
  buffer_load_dwordx4 v5, s[44:47], s60 offen lds
  s_setprio 0
  s_waitcnt lgkmcnt(0)
  s_add_u32 s68, s32, 12845056
  s_addc_u32 s69, s33, 0
  s_load_dwordx2 s[34:35], s[68:69], 0
  s_mov_b32 s36, s32
  s_mov_b32 s37, s33
  s_mov_b32 s38, 16777216
  s_mov_b32 s39, 0x20000
  v_mov_b32 v16, 0
  v_mov_b32 v17, 0
  v_lshl_add_u32 v18, v1, 2, s54
  s_mov_b32 exec_lo, 0x1ff
  s_mov_b32 exec_hi, 0x0
  ds_write_b32 v18, v16 offset:4092
  s_mul_i32 s49, s50, 4608
  s_add_u32 s49, s49, 147712
  s_mov_b32 exec_lo, -1
  s_mov_b32 exec_hi, 0x0fffffff
  v_lshl_add_u32 v18, v1, 3, s49
  ds_write_b64 v18, v[16:17]
  s_mov_b64 exec, -1
  s_mul_i32 s62, s50, 3072
  s_add_u32 s62, s62, 156928
  v_and_b32 v17, 15, v1
  v_and_b32 v18, 7, v17
  v_lshrrev_b32 v19, 3, v17
  v_lshl_add_u32 v18, v19, 7, v18
  v_cvt_f32_u32 v112, v18
  v_and_b32 v18, 3, v17
  v_lshlrev_b32 v18, 1, v18
  v_bfe_u32 v20, v17, 2, 1
  v_lshl_add_u32 v18, v20, 7, v18
  v_add_u32 v18, 256, v18
  v_and_b32 v20, 1, v17
  v_lshlrev_b32 v20, 2, v20
  v_bfe_u32 v21, v17, 1, 2
  v_lshl_add_u32 v20, v21, 7, v20
  v_add_u32 v20, 512, v20
  v_cmp_gt_u32 vcc, 8, v17
  s_nop 1
  v_cndmask_b32 v18, v20, v18, vcc
  v_cvt_f32_u32 v114, v18
  v_lshlrev_b32 v18, 7, v17
  v_add_u32 v18, 1024, v18
  v_cvt_f32_u32 v116, v18
  v_lshlrev_b32 v18, 3, v17
  v_cvt_f32_u32 v118, v18
  v_lshrrev_b32 v19, 4, v1
  v_and_b32 v20, 1, v19
  v_lshrrev_b32 v21, 1, v19
  v_lshlrev_b32 v22, 5, v17
  v_lshl_add_u32 v22, v20, 4, v22
  v_lshl_add_u32 v22, v21, 9, v22
  v_add_u32 v120, s62, v22
  v_lshlrev_b32 v22, 4, v17
  v_lshl_add_u32 v22, v20, 8, v22
  v_add_u32 v22, 1024, v22
  v_lshlrev_b32 v23, 3, v17
  v_lshl_add_u32 v23, v20, 8, v23
  v_add_u32 v23, 1536, v23
  v_cmp_gt_u32 vcc, 2, v19
  v_mov_b32 v24, 128
  s_nop 0
  v_cndmask_b32 v22, v23, v22, vcc
  v_cndmask_b32 v24, v24, 8, vcc
  v_add_u32 v121, s62, v22
  v_add_u32 v122, v121, v24
  v_lshlrev_b32 v22, 2, v17
  v_lshl_add_u32 v22, v19, 8, v22
  v_add_u32 v22, 2048, v22
  v_add_u32 v123, s62, v22
  v_mov_b32 v80, 0
  v_mov_b32 v81, 0
  v_mov_b32 v82, 0
  v_mov_b32 v83, 0
  v_mov_b32 v84, 0
  v_mov_b32 v85, 0
  v_mov_b32 v86, 0
  v_mov_b32 v87, 0
  v_mov_b32 v88, 0
  v_mov_b32 v89, 0
  v_mov_b32 v90, 0
  v_mov_b32 v91, 0
  v_lshl_add_u32 v20, v1, 4, s54
  v_lshrrev_b32 v6, 4, v1
  v_lshl_add_u32 v6, v6, 8, s54
  v_lshrrev_b32 v4, 2, v1
  v_lshlrev_b32 v4, 5, v4
  v_and_b32 v5, 3, v1
  v_lshl_add_u32 v4, v5, 3, v4
  v_add_u32 v4, s54, v4
  v_and_b32 v5, 15, v1
  v_mul_u32_u24 v5, 144, v5
  v_lshrrev_b32 v7, 4, v1
  v_lshl_add_u32 v5, v7, 3, v5
  v_add_u32 v154, s54, v5
  v_lshrrev_b32 v7, 3, v1
  v_and_b32 v5, 7, v1
  v_lshlrev_b32 v5, 4, v5
  v_mul_u32_u24 v155, 144, v7
  v_add3_u32 v155, v155, v5, s54
  v_lshl_add_u32 v5, v7, 12, v5
  s_lshl_b32 s59, s58, 16
  s_lshl_b32 s60, s57, 7
  s_add_u32 s59, s59, s60
  s_add_u32 s59, s59, 8388608
  s_add_u32 s58, s59, 0x8000
  s_and_b32 s60, s2, 7
  s_lshl_b32 s60, s60, 8
  s_and_b32 s61, s2, 0xf8
  s_add_u32 s60, s60, s61
  s_lshl_b32 s60, s60, 5
  s_add_u32 s60, s60, 12582912
  s_lshr_b32 s61, s2, 5
  s_lshl_b32 s61, s61, 8
  s_lshl_b32 s61, s61, 5
  s_add_u32 s61, s61, 12582912
  s_lshl_b32 s48, s2, 3
  s_lshl_b32 s48, s48, 5
  s_add_u32 s48, s48, 12713984
  v_lshlrev_b32 v152, 8, v1
  v_lshlrev_b32 v153, 4, v1
  s_lshl_b32 s64, s52, 12
  s_lshl_b32 s65, s53, 10
  s_add_u32 s65, s65, s64
  s_add_u32 s65, s65, 8388608
  s_add_u32 s64, s64, 10485760
  s_waitcnt lgkmcnt(0)
  s_add_u32 s34, s34, 1
  s_waitcnt vmcnt(2)
  v_lshlrev_b32 v8, 16, v8
  v_lshlrev_b32 v9, 16, v9
  v_lshlrev_b32 v10, 16, v10
  v_lshlrev_b32 v11, 16, v11
  v_lshlrev_b32 v12, 16, v12
  v_lshlrev_b32 v13, 16, v13
  v_lshlrev_b32 v14, 16, v14
  v_mul_f32 v14, 0x3fb8aa3b, v14
  v_exp_f32 v14, v14
  s_nop 0
  v_cvt_pk_bf16_f32 v14, v14, v14
  v_and_b32 v14, 0xffff0000, v14
  v_mul_f32 v16, v14, v8
  v_mul_f32 v17, v14, v9
  v_mul_f32 v10, v14, v10
  v_mul_f32 v11, v14, v11
  v_mul_f32 v16, 0x3fb8aa3b, v16
  v_mul_f32 v17, 0.15915494, v17
  v_mul_f32 v18, v12, v10
  v_mul_f32 v19, v12, v11
  v_fma_f32 v18, -v13, v11, v18
  v_fma_f32 v19, v13, v10, v19
  ds_write_b128 v20, v[16:19] offset:2560
  ds_read_b128 v[16:19], v6 offset:2560
  ds_read_b128 v[20:23], v6 offset:2576
  ds_read_b128 v[24:27], v6 offset:2592
  ds_read_b128 v[28:31], v6 offset:2608
  ds_read_b128 v[32:35], v6 offset:2624
  ds_read_b128 v[36:39], v6 offset:2640
  ds_read_b128 v[40:43], v6 offset:2656
  ds_read_b128 v[44:47], v6 offset:2672
  ds_read_b128 v[48:51], v6 offset:2688
  ds_read_b128 v[52:55], v6 offset:2704
  ds_read_b128 v[56:59], v6 offset:2720
  ds_read_b128 v[60:63], v6 offset:2736
  ds_read_b128 v[64:67], v6 offset:2752
  ds_read_b128 v[68:71], v6 offset:2768
  ds_read_b128 v[72:75], v6 offset:2784
  ds_read_b128 v[76:79], v6 offset:2800
  s_waitcnt vmcnt(0)
  ds_read_b64_tr_b16 v[156:157], v4 offset:0
  ds_read_b64_tr_b16 v[158:159], v4 offset:512
  ds_read_b64_tr_b16 v[160:161], v4 offset:1024
  ds_read_b64_tr_b16 v[162:163], v4 offset:1536
  s_waitcnt lgkmcnt(0)
  ds_write_b64 v154, v[156:157] offset:0
  ds_write_b64 v154, v[158:159] offset:32
  ds_write_b64 v154, v[160:161] offset:64
  ds_write_b64 v154, v[162:163] offset:96
  ds_read_b128 v[156:159], v155 offset:0
  ds_read_b128 v[160:163], v155 offset:1152
  s_mov_b32 s63, 0
  s_mov_b32 s71, 0
  s_waitcnt lgkmcnt(0)
L_kg:
  s_lshl_b32 s67, s63, 4
  s_set_gpr_idx_on s67, gpr_idx(SRC0)
  v_mov_b32 v96, v16
  v_mov_b32 v97, v17
  v_mov_b32 v98, v18
  v_mov_b32 v99, v19
  v_mov_b32 v100, v20
  v_mov_b32 v101, v21
  v_mov_b32 v102, v22
  v_mov_b32 v103, v23
  v_mov_b32 v104, v24
  v_mov_b32 v105, v25
  v_mov_b32 v106, v26
  v_mov_b32 v107, v27
  v_mov_b32 v108, v28
  v_mov_b32 v109, v29
  v_mov_b32 v110, v30
  v_mov_b32 v111, v31
  s_set_gpr_idx_off
  v_mul_f32 v9, v97, v118
  v_mul_f32 v137, v97, v112
  v_mul_f32 v143, v97, v114
  v_mul_f32 v149, v97, v116
  v_mul_f32 v8, v96, v118
  v_mul_f32 v136, v96, v112
  v_mul_f32 v142, v96, v114
  v_mul_f32 v148, v96, v116
  v_fract_f32 v9, v9
  v_fract_f32 v137, v137
  v_fract_f32 v143, v143
  v_fract_f32 v149, v149
  v_exp_f32 v8, v8
  v_exp_f32 v136, v136
  v_exp_f32 v142, v142
  v_exp_f32 v148, v148
  v_cos_f32 v10, v9
  v_cos_f32 v138, v137
  v_cos_f32 v144, v143
  v_cos_f32 v150, v149
  v_sin_f32 v11, v9
  v_sin_f32 v139, v137
  v_sin_f32 v145, v143
  v_sin_f32 v151, v149
  v_mul_f32 v10, v10, v8
  v_mul_f32 v138, v138, v136
  v_mul_f32 v144, v144, v142
  v_mul_f32 v150, v150, v148
  v_mul_f32 v11, v11, v8
  v_mul_f32 v139, v139, v136
  v_mul_f32 v145, v145, v142
  v_mul_f32 v151, v151, v148
  v_mul_f32 v9, v98, v10
  v_mul_f32 v12, -v98, v11
  v_cvt_pk_bf16_f32 v124, v138, v139
  v_cvt_pk_bf16_f32 v128, v144, v145
  v_cvt_pk_bf16_f32 v132, v150, v151
  v_fma_f32 v9, -v99, v11, v9
  v_fma_f32 v12, -v99, v10, v12
  v_cvt_pk_bf16_f32 v92, v9, v12
  s_setprio 3
  s_cmp_eq_u32 s63, 1
  s_cbranch_scc1 L_kg1
  s_cmp_gt_u32 s63, 1
  s_cbranch_scc1 L_kg2
  s_waitcnt lgkmcnt(0)
  buffer_store_dwordx4 v[156:159], v5, s[36:39], s59 offen sc1
  buffer_store_dwordx4 v[160:163], v5, s[36:39], s58 offen sc1
  s_branch L_kgx
L_kg1:
  s_waitcnt vmcnt(0)
  s_mov_b64 exec, 1
  ds_add_rtn_u32 v156, v2, v3 offset:120
  v_mov_b32 v158, s34
  v_mov_b32 v159, s35
  v_mov_b32 v157, 0
  s_waitcnt lgkmcnt(0)
  v_readfirstlane_b32 s68, v156
  s_nop 0
  s_cmp_lg_u32 s68, 3
  s_cbranch_scc1 Lpb60
  buffer_store_dwordx2 v[158:159], v157, s[36:39], s60 offen sc1
Lpb60:
  s_mov_b64 exec, -1
  s_branch L_kgx
L_kg2:
  s_cmp_lg_u32 s51, 0
  s_cbranch_scc1 L_kgx
  s_mov_b32 exec_lo, 0xffffffff
  s_mov_b32 exec_hi, 0x0
  s_cmp_eq_u32 s63, 2
  s_cbranch_scc1 L_kg3
  s_waitcnt vmcnt(0)
  v_cmp_eq_u64 vcc, s[34:35], v[156:157]
  s_nop 3
  s_cmp_eq_u64 vcc, exec
  s_cselect_b32 s71, 1, 0
  v_mov_b32 v158, s71
  ds_write_b32 v2, v158 offset:140
L_kg3:
  buffer_load_dwordx2 v[156:157], v152, s[36:39], s61 offen sc1
  s_mov_b64 exec, -1
L_kgx:
  s_setprio 0
  v_mul_f32 v9, v101, v118
  v_mul_f32 v137, v101, v112
  v_mul_f32 v143, v101, v114
  v_mul_f32 v149, v101, v116
  v_mul_f32 v8, v100, v118
  v_mul_f32 v136, v100, v112
  v_mul_f32 v142, v100, v114
  v_mul_f32 v148, v100, v116
  v_fract_f32 v9, v9
  v_fract_f32 v137, v137
  v_fract_f32 v143, v143
  v_fract_f32 v149, v149
  v_exp_f32 v8, v8
  v_exp_f32 v136, v136
  v_exp_f32 v142, v142
  v_exp_f32 v148, v148
  v_cos_f32 v10, v9
  v_cos_f32 v138, v137
  v_cos_f32 v144, v143
  v_cos_f32 v150, v149
  v_sin_f32 v11, v9
  v_sin_f32 v139, v137
  v_sin_f32 v145, v143
  v_sin_f32 v151, v149
  v_mul_f32 v10, v10, v8
  v_mul_f32 v138, v138, v136
  v_mul_f32 v144, v144, v142
  v_mul_f32 v150, v150, v148
  v_mul_f32 v11, v11, v8
  v_mul_f32 v139, v139, v136
  v_mul_f32 v145, v145, v142
  v_mul_f32 v151, v151, v148
  v_mul_f32 v9, v102, v10
  v_mul_f32 v12, -v102, v11
  v_cvt_pk_bf16_f32 v125, v138, v139
  v_cvt_pk_bf16_f32 v129, v144, v145
  v_cvt_pk_bf16_f32 v133, v150, v151
  v_fma_f32 v9, -v103, v11, v9
  v_fma_f32 v12, -v103, v10, v12
  v_cvt_pk_bf16_f32 v93, v9, v12
  v_mul_f32 v9, v105, v118
  v_mul_f32 v137, v105, v112
  v_mul_f32 v143, v105, v114
  v_mul_f32 v149, v105, v116
  v_mul_f32 v8, v104, v118
  v_mul_f32 v136, v104, v112
  v_mul_f32 v142, v104, v114
  v_mul_f32 v148, v104, v116
  v_fract_f32 v9, v9
  v_fract_f32 v137, v137
  v_fract_f32 v143, v143
  v_fract_f32 v149, v149
  v_exp_f32 v8, v8
  v_exp_f32 v136, v136
  v_exp_f32 v142, v142
  v_exp_f32 v148, v148
  v_cos_f32 v10, v9
  v_cos_f32 v138, v137
  v_cos_f32 v144, v143
  v_cos_f32 v150, v149
  v_sin_f32 v11, v9
  v_sin_f32 v139, v137
  v_sin_f32 v145, v143
  v_sin_f32 v151, v149
  v_mul_f32 v10, v10, v8
  v_mul_f32 v138, v138, v136
  v_mul_f32 v144, v144, v142
  v_mul_f32 v150, v150, v148
  v_mul_f32 v11, v11, v8
  v_mul_f32 v139, v139, v136
  v_mul_f32 v145, v145, v142
  v_mul_f32 v151, v151, v148
  v_mul_f32 v9, v106, v10
  v_mul_f32 v12, -v106, v11
  v_cvt_pk_bf16_f32 v126, v138, v139
  v_cvt_pk_bf16_f32 v130, v144, v145
  v_cvt_pk_bf16_f32 v134, v150, v151
  v_fma_f32 v9, -v107, v11, v9
  v_fma_f32 v12, -v107, v10, v12
  v_cvt_pk_bf16_f32 v94, v9, v12
  v_mul_f32 v9, v109, v118
  v_mul_f32 v137, v109, v112
  v_mul_f32 v143, v109, v114
  v_mul_f32 v149, v109, v116
  v_mul_f32 v8, v108, v118
  v_mul_f32 v136, v108, v112
  v_mul_f32 v142, v108, v114
  v_mul_f32 v148, v108, v116
  v_fract_f32 v9, v9
  v_fract_f32 v137, v137
  v_fract_f32 v143, v143
  v_fract_f32 v149, v149
  v_exp_f32 v8, v8
  v_exp_f32 v136, v136
  v_exp_f32 v142, v142
  v_exp_f32 v148, v148
  v_cos_f32 v10, v9
  v_cos_f32 v138, v137
  v_cos_f32 v144, v143
  v_cos_f32 v150, v149
  v_sin_f32 v11, v9
  v_sin_f32 v139, v137
  v_sin_f32 v145, v143
  v_sin_f32 v151, v149
  v_mul_f32 v10, v10, v8
  v_mul_f32 v138, v138, v136
  v_mul_f32 v144, v144, v142
  v_mul_f32 v150, v150, v148
  v_mul_f32 v11, v11, v8
  v_mul_f32 v139, v139, v136
  v_mul_f32 v145, v145, v142
  v_mul_f32 v151, v151, v148
  v_mul_f32 v9, v110, v10
  v_mul_f32 v12, -v110, v11
  v_cvt_pk_bf16_f32 v127, v138, v139
  v_cvt_pk_bf16_f32 v131, v144, v145
  v_cvt_pk_bf16_f32 v135, v150, v151
  v_fma_f32 v9, -v111, v11, v9
  v_fma_f32 v12, -v111, v10, v12
  v_cvt_pk_bf16_f32 v95, v9, v12
  s_add_u32 s63, s63, 1
  s_nop 0
  s_cmp_lt_u32 s63, 4
  v_mfma_f32_16x16x32_bf16 v[80:83], v[124:127], v[92:95], v[80:83]
  v_mfma_f32_16x16x32_bf16 v[84:87], v[128:131], v[92:95], v[84:87]
  v_mfma_f32_16x16x32_bf16 v[88:91], v[132:135], v[92:95], v[88:91]
  s_cbranch_scc1 L_kg
  s_setprio 3
  s_cmp_lg_u32 s51, 0
  s_cbranch_scc1 L_xmy
  s_cmp_eq_u32 s71, 1
  s_cbranch_scc1 L_xmy2
  s_mov_b32 s70, 0x40000
  s_mov_b32 exec_lo, 0xffffffff
  s_mov_b32 exec_hi, 0x0
  s_branch Lpc63
Lpf61:
  s_sleep 4
Lpi64:
  buffer_load_dwordx2 v[156:157], v152, s[36:39], s61 offen sc1
Lpc63:
  s_sub_u32 s70, s70, 1
  s_cbranch_scc1 Lpk62
  s_waitcnt vmcnt(0)
  v_cmp_eq_u64 vcc, s[34:35], v[156:157]
  s_nop 3
  s_cmp_eq_u64 vcc, exec
  s_cbranch_scc0 Lpf61
Lpk62:
  s_mov_b64 exec, -1
  ds_write_b32 v2, v3 offset:140
  s_branch L_xmy2
L_xmy:
  s_mov_b32 s70, 0x400000
Lsp65:
  s_sleep 1
  ds_read_b32 v156, v2 offset:140
  s_sub_u32 s70, s70, 1
  s_cbranch_scc1 Lok66
  s_waitcnt lgkmcnt(0)
  v_readfirstlane_b32 s68, v156
  s_nop 0
  s_cmp_lt_u32 s68, 1
  s_cbranch_scc1 Lsp65
Lok66:
L_xmy2:
  s_waitcnt vmcnt(0)
  buffer_load_dwordx4 v[156:159], v153, s[36:39], s65 offen sc1
  s_cmp_eq_u32 s53, 0
  s_cbranch_scc1 L_xu0
  buffer_load_dwordx4 v[160:163], v153, s[36:39], s65 offen offset:1024 sc1
  buffer_load_dwordx4 v[164:167], v153, s[36:39], s65 offen offset:2048 sc1
L_xu0:
  s_setprio 2
  s_lshl_b32 s66, s50, 2
  v_add_u32 v4, s66, v2
  s_mul_i32 s66, s50, 8320
  s_lshl_b32 s67, s53, 11
  s_add_u32 s67, s67, s66
  s_add_u32 s67, s67, 131072
  v_add_u32 v5, s67, v153
  v_add_u32 v6, s49, v153
  s_cmp_eq_u32 s53, 0
  s_cbranch_scc1 L_xw0
  ds_write_b128 v6, v[88:91] offset:480
  s_branch L_xw1
L_xw0:
  ds_write_b128 v6, v[80:83] offset:1504
  ds_write_b128 v6, v[84:87] offset:2528
  ds_write_b128 v6, v[88:91] offset:3552
L_xw1:
  s_mov_b64 exec, 1
  ds_add_u32 v4, v3 offset:104
  s_mov_b64 exec, -1
  s_add_u32 s67, s53, 2
  v_lshlrev_b32 v96, s67, v1
  s_mul_i32 s67, s53, 260
  s_sub_u32 s67, 2300, s67
  s_add_u32 s67, s67, s62
  v_sub_u32 v96, s67, v96
  v_sub_u32 v98, 63, v1
  v_lshlrev_b32 v97, 5, v98
  v_lshlrev_b32 v98, 4, v98
  v_add_u32 v98, 512, v98
  v_cmp_gt_u32 vcc, 32, v1
  s_nop 1
  v_cndmask_b32 v97, v97, v98, vcc
  v_add_u32 v97, s62, v97
  s_mov_b32 s70, 0x400000
Lsp67:
  s_sleep 1
  ds_read_b32 v7, v4 offset:104
  s_sub_u32 s70, s70, 1
  s_cbranch_scc1 Lok68
  s_waitcnt lgkmcnt(0)
  v_readfirstlane_b32 s68, v7
  s_nop 0
  s_cmp_lt_u32 s68, 2
  s_cbranch_scc1 Lsp67
Lok68:
  s_cmp_eq_u32 s53, 0
  s_cbranch_scc1 L_xr0
  ds_read_b128 v[16:19], v6 offset:1504
  ds_read_b128 v[20:23], v6 offset:2528
  ds_read_b128 v[24:27], v6 offset:3552
  s_waitcnt lgkmcnt(0)
  v_add_f32 v80, v80, v16
  v_add_f32 v81, v81, v17
  v_add_f32 v82, v82, v18
  v_add_f32 v83, v83, v19
  v_add_f32 v84, v84, v20
  v_add_f32 v85, v85, v21
  v_add_f32 v86, v86, v22
  v_add_f32 v87, v87, v23
  v_add_f32 v88, v88, v24
  ds_write_b128 v120, v[80:83]
  ds_write_b64 v121, v[84:85]
  ds_write_b64 v122, v[86:87]
  s_mov_b64 exec, 1
  ds_write_b32 v123, v88
  s_mov_b64 exec, -1
  ds_read_b64 v[16:17], v96
  ds_read_b32 v18, v96 offset:8
  ds_read_b128 v[20:23], v97
  ds_read_b128 v[24:27], v97 offset:16
  s_mov_b32 vcc_lo, -1
  s_mov_b32 vcc_hi, 0
  s_waitcnt lgkmcnt(2)
  v_cvt_pk_bf16_f32 v48, v18, v18
  v_cvt_pk_bf16_f32 v49, v17, v17
  v_cvt_pk_bf16_f32 v50, v17, v16
  v_cvt_pk_bf16_f32 v51, v16, v16
  v_cvt_pk_bf16_f32 v52, v18, v17
  v_cvt_pk_bf16_f32 v53, v17, v17
  v_cvt_pk_bf16_f32 v54, v16, v16
  ds_write_b128 v5, v[48:51] offset:0
  ds_write_b96 v5, v[52:54] offset:4160
  ds_write_b16 v5, v48 offset:4158
  ds_write_b16_d16_hi v5, v51 offset:4172
  s_waitcnt lgkmcnt(4)
  v_cndmask_b32 v35, v27, v24, vcc
  v_cndmask_b32 v34, v26, v23, vcc
  v_cndmask_b32 v33, v25, v22, vcc
  v_cndmask_b32 v32, v24, v22, vcc
  v_cndmask_b32 v31, v23, v22, vcc
  v_cndmask_b32 v30, v22, v21, vcc
  v_cndmask_b32 v29, v21, v20, vcc
  v_cvt_pk_bf16_f32 v56, v35, v34
  v_cvt_pk_bf16_f32 v57, v33, v32
  v_cvt_pk_bf16_f32 v58, v31, v30
  v_cvt_pk_bf16_f32 v59, v29, v20
  v_cvt_pk_bf16_f32 v60, v34, v33
  v_cvt_pk_bf16_f32 v61, v32, v31
  v_cvt_pk_bf16_f32 v62, v30, v29
  ds_write_b128 v5, v[56:59] offset:1024
  ds_write_b96 v5, v[60:62] offset:5184
  ds_write_b16 v5, v56 offset:5182
  ds_write_b16_d16_hi v5, v59 offset:5196
  s_waitcnt vmcnt(0)
  ds_write_b128 v6, v[156:159] offset:1504
  ds_write_b128 v6, v[160:163] offset:2528
  ds_write_b128 v6, v[164:167] offset:3552
  s_branch L_xr1
L_xr0:
  ds_read_b128 v[16:19], v6 offset:480
  s_waitcnt lgkmcnt(0)
  v_add_f32 v88, v88, v16
  v_add_f32 v89, v89, v17
  v_add_f32 v90, v90, v18
  v_add_f32 v91, v91, v19
  ds_write_b32 v123, v88 offset:0
  ds_write_b32 v123, v89 offset:64
  ds_write_b32 v123, v90 offset:128
  ds_write_b32 v123, v91 offset:192
  ds_read2_b32 v[16:17], v96 offset0:64 offset1:65
  ds_read2_b32 v[18:19], v96 offset0:0 offset1:1
  s_mov_b32 vcc_lo, 0x55555555
  s_mov_b32 vcc_hi, 0x55555555
  s_waitcnt lgkmcnt(0)
  v_cndmask_b32 v20, v16, v17, vcc
  v_cndmask_b32 v21, v18, v19, vcc
  v_cvt_pk_bf16_f32 v48, v17, v17
  v_cvt_pk_bf16_f32 v49, v17, v20
  v_cvt_pk_bf16_f32 v50, v16, v16
  v_cvt_pk_bf16_f32 v51, v16, v16
  v_cvt_pk_bf16_f32 v52, v17, v17
  v_cvt_pk_bf16_f32 v53, v20, v16
  v_cvt_pk_bf16_f32 v54, v16, v16
  ds_write_b128 v5, v[48:51] offset:0
  ds_write_b96 v5, v[52:54] offset:4160
  ds_write_b16 v5, v48 offset:4158
  ds_write_b16_d16_hi v5, v51 offset:4172
  v_cvt_pk_bf16_f32 v56, v19, v19
  v_cvt_pk_bf16_f32 v57, v19, v21
  v_cvt_pk_bf16_f32 v58, v18, v18
  v_cvt_pk_bf16_f32 v59, v18, v18
  v_cvt_pk_bf16_f32 v60, v19, v19
  v_cvt_pk_bf16_f32 v61, v21, v18
  v_cvt_pk_bf16_f32 v62, v18, v18
  ds_write_b128 v5, v[56:59] offset:1024
  ds_write_b96 v5, v[60:62] offset:5184
  ds_write_b16 v5, v56 offset:5182
  ds_write_b16_d16_hi v5, v59 offset:5196
  s_waitcnt vmcnt(0)
  ds_write_b128 v6, v[156:159] offset:480
L_xr1:
  s_mov_b64 exec, 1
  ds_add_u32 v4, v3 offset:112
  s_mov_b64 exec, -1
L_attn:
  s_and_b32 s55, s3, 3
  s_lshr_b32 s56, s3, 2
  s_lshl_b32 s52, s96, 2
  s_add_u32 s52, s52, s55
  s_lshl_b32 s58, s52, 1
  s_add_u32 s58, s58, s56
  s_mul_i32 s58, s58, 32768
  s_add_u32 s62, s58, 2097152
  s_add_u32 s58, s58, 4718592
  s_lshl_b32 s53, s96, 13
  s_add_u32 s53, s53, 12648448
  v_and_b32 v5, 51, v1
  v_bfe_u32 v162, v1, 3, 1
  v_lshl_add_u32 v5, v162, 2, v5
  v_bfe_u32 v162, v1, 2, 1
  v_lshl_add_u32 v5, v162, 3, v5
  v_lshlrev_b32 v5, 4, v5
  v_and_b32 v162, 15, v1
  v_lshlrev_b32 v162, 4, v162
  v_lshrrev_b32 v163, 5, v1
  v_lshl_add_u32 v162, v163, 8, v162
  v_add_u32 v166, 2621440, v162
  v_and_b32 v163, 27, v1
  v_cmp_eq_u32 vcc, 16, v163
  v_mov_b32 v164, 0x3f803f80
  s_mov_b32 s50, 0xffff
  s_mov_b32 s51, 0xffff
  v_cndmask_b32 v164, 0, v164, vcc
  v_mov_b32 v128, v164
  v_mov_b32 v129, v164
  v_mov_b32 v130, v164
  v_mov_b32 v131, v164
  v_mov_b32 v132, v164
  v_mov_b32 v133, v164
  v_mov_b32 v134, v164
  v_mov_b32 v135, v164
  v_mov_b32 v136, v164
  v_mov_b32 v137, v164
  v_mov_b32 v138, v164
  v_mov_b32 v139, v164
  v_mov_b32 v140, v164
  v_mov_b32 v141, v164
  v_mov_b32 v142, v164
  v_mov_b32 v143, v164
  v_mov_b32 v144, v164
  v_mov_b32 v145, v164
  v_mov_b32 v146, v164
  v_mov_b32 v147, v164
  v_mov_b32 v148, v164
  v_mov_b32 v149, v164
  v_mov_b32 v150, v164
  v_mov_b32 v151, v164
  v_mov_b32 v152, v164
  v_mov_b32 v153, v164
  v_mov_b32 v154, v164
  v_mov_b32 v155, v164
  v_mov_b32 v156, v164
  v_mov_b32 v157, v164
  v_mov_b32 v158, v164
  v_mov_b32 v159, v164
  v_mov_b32 v4, 0xdddddddd
  v_lshlrev_b32 v167, 4, v1
  s_lshl_b32 s60, s95, 3
  s_add_u32 s60, s60, s96
  s_lshl_b32 s60, s60, 8
  s_add_u32 s60, s60, 12779520
  s_cmp_lt_u32 s3, 4
  s_cselect_b32 s54, 8, 6
L_attn2:
  s_mov_b32 s64, 0
  s_setprio 0
  s_mov_b32 s70, 0x40000
  s_and_b32 s57, s2, 3
  s_cmp_lg_u32 s3, 0
  s_cbranch_scc1 Lwo72
  s_branch Lwg71
Lwf69:
  s_sleep 2
Lwg71:
  v_lshlrev_b32 v164, 8, v1
  s_mov_b32 exec_lo, 0xffffffff
  s_mov_b32 exec_hi, 0x0
  buffer_load_dwordx2 v[162:163], v164, s[36:39], s53 offen sc1
  s_waitcnt vmcnt(0)
  v_cmp_eq_u64 vcc, s[34:35], v[162:163]
  s_mov_b64 exec, -1
  s_nop 2
  s_lshr_b32 s63, vcc_lo, 1
  s_and_b32 s63, vcc_lo, s63
  s_lshr_b32 s58, s63, 2
  s_and_b32 s63, s63, s58
  s_lshr_b32 s58, s63, 4
  s_and_b32 s63, s63, 0x01010101
  s_mul_i32 s63, s63, 0x10204080
  s_lshr_b32 s63, s63, 28
  s_and_b32 s58, s58, 0x01010101
  s_mul_i32 s58, s58, 0x10204080
  s_lshr_b32 s58, s58, 28
  v_mov_b32 v162, s63
  v_mov_b32 v163, s58
  ds_write_b64 v2, v[162:163] offset:152
  s_and_b32 s59, s63, s58
  s_sub_u32 s70, s70, 1
  s_cbranch_scc1 Lwk70
  s_bitcmp1_b32 s59, s57
  s_cbranch_scc0 Lwf69
  s_branch Lwk70
Lwo72:
  s_mov_b32 s70, 0x400000
  s_lshl_b32 s58, s56, 2
  v_add_u32 v163, s58, v2
Lwl73:
  s_sleep 1
  ds_read_b32 v162, v163 offset:152
  s_sub_u32 s70, s70, 1
  s_cbranch_scc1 Lwk70
  s_waitcnt lgkmcnt(0)
  v_readfirstlane_b32 s63, v162
  s_nop 0
  s_bitcmp1_b32 s63, s57
  s_cbranch_scc0 Lwl73
Lwk70:
  s_lshl_b32 s57, s57, 1
  s_setprio 3
  s_lshl_b32 s58, s57, 12
  s_add_u32 s61, s62, s58
  buffer_load_dwordx4 v[112:115], v5, s[36:39], s61 offen offset:0 sc1
  buffer_load_dwordx4 v[116:119], v5, s[36:39], s61 offen offset:1024 sc1
  s_mov_b64 exec, s[50:51]
  buffer_load_dwordx4 v[128:131], v166, s[36:39], s61 offen offset:0 sc1
  buffer_load_dwordx4 v[132:135], v166, s[36:39], s61 offen offset:512 sc1
  s_mov_b64 exec, -1
  buffer_load_dwordx4 v[120:123], v5, s[36:39], s61 offen offset:2048 sc1
  s_mov_b64 exec, s[50:51]
  buffer_load_dwordx4 v[136:139], v166, s[36:39], s61 offen offset:1024 sc1
  buffer_load_dwordx4 v[140:143], v166, s[36:39], s61 offen offset:1536 sc1
  s_mov_b64 exec, -1
  buffer_load_dwordx4 v[124:127], v5, s[36:39], s61 offen offset:3072 sc1
  s_mov_b64 exec, s[50:51]
  buffer_load_dwordx4 v[144:147], v166, s[36:39], s61 offen offset:2048 sc1
  buffer_load_dwordx4 v[148:151], v166, s[36:39], s61 offen offset:2560 sc1
  s_mov_b64 exec, -1
  s_mov_b32 s59, s61
  s_add_u32 s61, s61, 4096
  s_add_u32 s67, s58, 4096
  s_lshl_b32 s58, s63, 4
  s_or_b32 s58, s58, s63
  s_lshr_b32 s66, s57, 1
  s_lshr_b32 s58, s58, s66
  s_not_b32 s58, s58
  s_and_b32 s58, s58, 15
  s_or_b32 s58, s58, 16
  s_ff1_i32_b32 s58, s58
  s_lshr_b32 s66, s58, 2
  s_lshl_b32 s58, s58, 1
  s_add_u32 s66, s66, s58
  s_sub_u32 s66, s66, 1
  s_max_i32 s66, s66, 1
  s_min_u32 s66, s66, s54
  s_lshl_b32 s58, s55, 11
  v_add_u32 v163, s58, v5
  v_mov_b32 v80, 0
  v_mov_b32 v81, 0
  v_mov_b32 v82, 0
  v_mov_b32 v83, 0
  v_mov_b32 v84, 0
  v_mov_b32 v85, 0
  v_mov_b32 v86, 0
  v_mov_b32 v87, 0
  v_mov_b32 v88, 0
  v_mov_b32 v96, 0
  v_mov_b32 v97, 0
  v_mov_b32 v98, 0
  v_mov_b32 v99, 0
  v_mov_b32 v100, 0
  v_mov_b32 v101, 0
  v_mov_b32 v102, 0
  v_mov_b32 v103, 0
  v_mov_b32 v104, 0
  s_mov_b32 s70, 0x400000
Lsp74:
  s_sleep 1
  ds_read_b32 v162, v2 offset:144
  s_sub_u32 s70, s70, 1
  s_cbranch_scc1 Lok75
  s_waitcnt lgkmcnt(0)
  v_readfirstlane_b32 s68, v162
  s_nop 0
  s_cmp_lt_u32 s68, 4
  s_cbranch_scc1 Lsp74
Lok75:
  ds_read_b128 v[8:11], v163 offset:0
  ds_read_b128 v[12:15], v163 offset:1024
  ds_read_b128 v[64:67], v163 offset:8192
  s_waitcnt lgkmcnt(0)
  v_mfma_f32_32x32x16_bf16 v[16:31], v[64:67], v[8:11], 0
  v_mfma_f32_32x32x16_bf16 v[32:47], v[64:67], v[12:15], 0
  s_nop 10
  v_max3_f32 v160, v16, v17, v18
  v_max3_f32 v160, v160, v19, v20
  v_max3_f32 v160, v160, v21, v22
  v_max3_f32 v160, v160, v23, v24
  v_max3_f32 v160, v160, v25, v26
  v_max3_f32 v160, v160, v27, v28
  v_max3_f32 v160, v160, v29, v30
  v_max_f32 v160, v160, v31
  v_max3_f32 v161, v32, v33, v34
  v_max3_f32 v161, v161, v35, v36
  v_max3_f32 v161, v161, v37, v38
  v_max3_f32 v161, v161, v39, v40
  v_max3_f32 v161, v161, v41, v42
  v_max3_f32 v161, v161, v43, v44
  v_max3_f32 v161, v161, v45, v46
  v_max_f32 v161, v161, v47
L_start:
  v_mov_b32 v162, v160
  v_mov_b32 v163, v161
  s_mov_b32 s65, 0
  s_nop 0
  v_permlane32_swap_b32 v160, v162
  v_permlane32_swap_b32 v161, v163
  s_nop 0
  v_max_f32 v160, v160, v162
  v_max_f32 v161, v161, v163
  v_sub_f32 v48, 0, v160
  v_sub_f32 v49, 0, v160
  v_sub_f32 v50, 0, v160
  v_sub_f32 v51, 0, v160
  v_sub_f32 v52, 0, v160
  v_sub_f32 v53, 0, v160
  v_sub_f32 v54, 0, v160
  v_sub_f32 v55, 0, v160
  v_sub_f32 v56, 0, v160
  v_sub_f32 v57, 0, v160
  v_sub_f32 v58, 0, v160
  v_sub_f32 v59, 0, v160
  v_sub_f32 v60, 0, v160
  v_sub_f32 v61, 0, v160
  v_sub_f32 v62, 0, v160
  v_sub_f32 v63, 0, v160
  s_nop 0
  s_waitcnt vmcnt(9)
  v_mfma_f32_32x32x16_bf16 v[16:31], v[112:115], v[8:11], v[48:63]
  v_sub_f32 v64, 0, v161
  v_sub_f32 v65, 0, v161
  v_sub_f32 v66, 0, v161
  v_sub_f32 v67, 0, v161
  v_sub_f32 v68, 0, v161
  v_sub_f32 v69, 0, v161
  v_sub_f32 v70, 0, v161
  v_sub_f32 v71, 0, v161
  v_sub_f32 v72, 0, v161
  v_sub_f32 v73, 0, v161
  v_sub_f32 v74, 0, v161
  v_sub_f32 v75, 0, v161
  v_sub_f32 v76, 0, v161
  v_sub_f32 v77, 0, v161
  v_sub_f32 v78, 0, v161
  v_sub_f32 v79, 0, v161
  v_mov_b32 v40, 0
  v_mov_b32 v41, 0
  v_mov_b32 v42, 0
  v_mov_b32 v43, 0
  v_mov_b32 v44, 0
  v_mov_b32 v45, 0
  v_mov_b32 v46, 0
  v_mov_b32 v47, 0
  s_setprio 0
  s_cmp_lt_u32 s3, 4
  s_cbranch_scc1 L_loop
  s_setprio 1
.p2align 6
L_loop:
  v_exp_f32 v16, v16
  v_exp_f32 v17, v17
  v_smfmac_f32_32x32x32_bf16 v[96:111], v[156:159], v[40:47], v4
  v_exp_f32 v18, v18
  v_exp_f32 v19, v19
  v_exp_f32 v20, v20
  v_exp_f32 v21, v21
  v_mfma_f32_32x32x16_bf16 v[32:47], v[112:115], v[12:15], v[64:79]
  buffer_load_dwordx4 v[112:115], v5, s[36:39], s61 offen offset:0 sc1
  s_mov_b64 exec, s[50:51]
  buffer_load_dwordx4 v[152:155], v166, s[36:39], s59 offen offset:3072 sc1
  buffer_load_dwordx4 v[156:159], v166, s[36:39], s59 offen offset:3584 sc1
  s_mov_b64 exec, -1
  v_exp_f32 v22, v22
  v_exp_f32 v23, v23
  v_exp_f32 v24, v24
  v_exp_f32 v25, v25
  v_exp_f32 v26, v26
  s_waitcnt vmcnt(9)
  v_smfmac_f32_32x32x32_bf16 v[80:95], v[128:131], v[16:23], v4
  v_exp_f32 v27, v27
  v_exp_f32 v28, v28
  v_exp_f32 v29, v29
  v_exp_f32 v30, v30
  v_exp_f32 v31, v31
  v_exp_f32 v32, v32
  v_exp_f32 v33, v33
  v_smfmac_f32_32x32x32_bf16 v[80:95], v[132:135], v[24:31], v4
  v_exp_f32 v34, v34
  v_exp_f32 v35, v35
  v_exp_f32 v36, v36
  v_mfma_f32_32x32x16_bf16 v[16:31], v[116:119], v[8:11], v[48:63]
  v_exp_f32 v37, v37
  v_exp_f32 v38, v38
  v_exp_f32 v39, v39
  v_exp_f32 v40, v40
  v_exp_f32 v41, v41
  v_exp_f32 v42, v42
  v_smfmac_f32_32x32x32_bf16 v[96:111], v[128:131], v[32:39], v4
  v_exp_f32 v43, v43
  v_exp_f32 v44, v44
  v_exp_f32 v45, v45
  v_exp_f32 v46, v46
  v_exp_f32 v47, v47
  v_exp_f32 v16, v16
  v_exp_f32 v17, v17
  v_smfmac_f32_32x32x32_bf16 v[96:111], v[132:135], v[40:47], v4
  v_exp_f32 v18, v18
  v_exp_f32 v19, v19
  v_exp_f32 v20, v20
  v_exp_f32 v21, v21
  v_mfma_f32_32x32x16_bf16 v[32:47], v[116:119], v[12:15], v[64:79]
  buffer_load_dwordx4 v[116:119], v5, s[36:39], s61 offen offset:1024 sc1
  s_mov_b64 exec, s[50:51]
  buffer_load_dwordx4 v[128:131], v166, s[36:39], s61 offen offset:0 sc1
  buffer_load_dwordx4 v[132:135], v166, s[36:39], s61 offen offset:512 sc1
  s_mov_b64 exec, -1
  v_exp_f32 v22, v22
  v_exp_f32 v23, v23
  v_exp_f32 v24, v24
  v_exp_f32 v25, v25
  v_exp_f32 v26, v26
  s_waitcnt vmcnt(9)
  v_smfmac_f32_32x32x32_bf16 v[80:95], v[136:139], v[16:23], v4
  v_exp_f32 v27, v27
  v_exp_f32 v28, v28
  v_exp_f32 v29, v29
  v_exp_f32 v30, v30
  v_exp_f32 v31, v31
  v_exp_f32 v32, v32
  v_exp_f32 v33, v33
  v_smfmac_f32_32x32x32_bf16 v[80:95], v[140:143], v[24:31], v4
  v_exp_f32 v34, v34
  v_exp_f32 v35, v35
  v_exp_f32 v36, v36
  v_mfma_f32_32x32x16_bf16 v[16:31], v[120:123], v[8:11], v[48:63]
  v_exp_f32 v37, v37
  v_exp_f32 v38, v38
  v_exp_f32 v39, v39
  v_exp_f32 v40, v40
  v_exp_f32 v41, v41
  v_exp_f32 v42, v42
  v_smfmac_f32_32x32x32_bf16 v[96:111], v[136:139], v[32:39], v4
  v_exp_f32 v43, v43
  v_exp_f32 v44, v44
  v_exp_f32 v45, v45
  v_exp_f32 v46, v46
  v_exp_f32 v47, v47
  v_exp_f32 v16, v16
  v_exp_f32 v17, v17
  v_smfmac_f32_32x32x32_bf16 v[96:111], v[140:143], v[40:47], v4
  v_exp_f32 v18, v18
  v_exp_f32 v19, v19
  v_exp_f32 v20, v20
  v_exp_f32 v21, v21
  v_mfma_f32_32x32x16_bf16 v[32:47], v[120:123], v[12:15], v[64:79]
  buffer_load_dwordx4 v[120:123], v5, s[36:39], s61 offen offset:2048 sc1
  s_mov_b64 exec, s[50:51]
  buffer_load_dwordx4 v[136:139], v166, s[36:39], s61 offen offset:1024 sc1
  buffer_load_dwordx4 v[140:143], v166, s[36:39], s61 offen offset:1536 sc1
  s_mov_b64 exec, -1
  v_exp_f32 v22, v22
  v_exp_f32 v23, v23
  v_exp_f32 v24, v24
  v_exp_f32 v25, v25
  v_exp_f32 v26, v26
  s_waitcnt vmcnt(9)
  v_smfmac_f32_32x32x32_bf16 v[80:95], v[144:147], v[16:23], v4
  v_exp_f32 v27, v27
  v_exp_f32 v28, v28
  v_exp_f32 v29, v29
  v_exp_f32 v30, v30
  v_exp_f32 v31, v31
  v_exp_f32 v32, v32
  v_exp_f32 v33, v33
  v_smfmac_f32_32x32x32_bf16 v[80:95], v[148:151], v[24:31], v4
  v_exp_f32 v34, v34
  v_exp_f32 v35, v35
  v_exp_f32 v36, v36
  v_mfma_f32_32x32x16_bf16 v[16:31], v[124:127], v[8:11], v[48:63]
  v_exp_f32 v37, v37
  v_exp_f32 v38, v38
  v_exp_f32 v39, v39
  v_exp_f32 v40, v40
  v_exp_f32 v41, v41
  v_exp_f32 v42, v42
  v_smfmac_f32_32x32x32_bf16 v[96:111], v[144:147], v[32:39], v4
  v_exp_f32 v43, v43
  v_exp_f32 v44, v44
  v_exp_f32 v45, v45
  v_exp_f32 v46, v46
  v_exp_f32 v47, v47
  v_exp_f32 v16, v16
  v_exp_f32 v17, v17
  v_smfmac_f32_32x32x32_bf16 v[96:111], v[148:151], v[40:47], v4
  v_exp_f32 v18, v18
  v_exp_f32 v19, v19
  v_exp_f32 v20, v20
  v_exp_f32 v21, v21
  v_mfma_f32_32x32x16_bf16 v[32:47], v[124:127], v[12:15], v[64:79]
  buffer_load_dwordx4 v[124:127], v5, s[36:39], s61 offen offset:3072 sc1
  s_mov_b64 exec, s[50:51]
  buffer_load_dwordx4 v[144:147], v166, s[36:39], s61 offen offset:2048 sc1
  buffer_load_dwordx4 v[148:151], v166, s[36:39], s61 offen offset:2560 sc1
  s_mov_b64 exec, -1
  v_exp_f32 v22, v22
  v_exp_f32 v23, v23
  v_exp_f32 v24, v24
  v_exp_f32 v25, v25
  v_exp_f32 v26, v26
  s_waitcnt vmcnt(9)
  v_smfmac_f32_32x32x32_bf16 v[80:95], v[152:155], v[16:23], v4
  v_exp_f32 v27, v27
  v_exp_f32 v28, v28
  v_exp_f32 v29, v29
  v_exp_f32 v30, v30
  v_exp_f32 v31, v31
  v_exp_f32 v32, v32
  v_exp_f32 v33, v33
  v_smfmac_f32_32x32x32_bf16 v[80:95], v[156:159], v[24:31], v4
  v_exp_f32 v34, v34
  v_exp_f32 v35, v35
  v_exp_f32 v36, v36
  v_mfma_f32_32x32x16_bf16 v[16:31], v[112:115], v[8:11], v[48:63]
  v_exp_f32 v37, v37
  v_exp_f32 v38, v38
  v_exp_f32 v39, v39
  v_exp_f32 v40, v40
  v_exp_f32 v41, v41
  v_exp_f32 v42, v42
  v_smfmac_f32_32x32x32_bf16 v[96:111], v[152:155], v[32:39], v4
  s_mov_b32 s59, s61
  s_add_u32 s67, s67, 4096
  s_and_b32 s67, s67, 0x7fff
  s_add_u32 s61, s62, s67
  s_add_u32 s65, s65, 1
  s_cmp_lt_u32 s65, s66
  v_exp_f32 v43, v43
  v_exp_f32 v44, v44
  v_exp_f32 v45, v45
  v_exp_f32 v46, v46
  v_exp_f32 v47, v47
  s_cbranch_scc1 L_loop
  s_cmp_lt_u32 s65, 8
  s_cbranch_scc1 L_stub
  v_smfmac_f32_32x32x32_bf16 v[96:111], v[156:159], v[40:47], v4
  s_mul_i32 s58, s3, 2560
  s_add_u32 s58, s58, 16384
  s_xor_b32 s59, s3, 4
  s_mul_i32 s59, s59, 2560
  s_add_u32 s59, s59, 16384
  v_add_u32 v48, s58, v167
  v_add_u32 v49, s59, v167
  v_lshrrev_b32 v162, 1, v167
  v_add_u32 v163, s59, v162
  v_add_u32 v162, s58, v162
  s_lshl_b32 s58, s95, 1
  s_add_u32 s58, s58, s56
  s_lshl_b32 s58, s58, 15
  s_lshl_b32 s59, s52, 10
  s_add_u32 s58, s58, s59
  s_add_u32 s58, s58, 0
  v_add_f32 v165, v88, v104
  v_cmp_nge_f32 vcc, 0x53800000, v165
  s_cmp_lg_u32 s64, 0
  s_cbranch_scc1 L_fin
  s_nop 2
  s_cbranch_vccnz L_fallback
L_fin:
  s_cmp_eq_u32 s56, 0
  s_cbranch_scc1 L_noswap
  v_swap_b32 v80, v96
  v_swap_b32 v81, v97
  v_swap_b32 v82, v98
  v_swap_b32 v83, v99
  v_swap_b32 v84, v100
  v_swap_b32 v85, v101
  v_swap_b32 v86, v102
  v_swap_b32 v87, v103
  v_swap_b32 v88, v104
  v_swap_b32 v160, v161
L_noswap:
  v_mov_b32 v105, v161
  ds_write_b128 v48, v[96:99]
  ds_write_b128 v48, v[100:103] offset:1024
  ds_write_b64 v162, v[104:105] offset:2048
  s_lshl_b32 s59, s55, 2
  v_add_u32 v164, s59, v2
  s_mov_b64 exec, 1
  ds_add_u32 v164, v3 offset:164
  s_mov_b64 exec, -1
  s_mov_b32 s70, 0x400000
Lsp76:
  s_sleep 1
  ds_read_b32 v165, v164 offset:164
  s_sub_u32 s70, s70, 1
  s_cbranch_scc1 Lok77
  s_waitcnt lgkmcnt(0)
  v_readfirstlane_b32 s68, v165
  s_nop 0
  s_cmp_lt_u32 s68, 2
  s_cbranch_scc1 Lsp76
Lok77:
  ds_read_b64 v[24:25], v163 offset:2048
  ds_read_b128 v[16:19], v49
  ds_read_b128 v[20:23], v49 offset:1024
  s_waitcnt lgkmcnt(2)
  v_max_f32 v162, v160, v25
  v_sub_f32 v163, v160, v162
  v_sub_f32 v164, v25, v162
  v_exp_f32 v163, v163
  v_exp_f32 v164, v164
  s_nop 0
  v_mul_f32 v162, v88, v163
  v_fmac_f32 v162, v24, v164
  v_rcp_f32 v162, v162
  s_nop 0
  v_mul_f32 v163, v163, v162
  v_mul_f32 v164, v164, v162
  s_waitcnt lgkmcnt(0)
  v_mul_f32 v80, v80, v163
  v_mul_f32 v81, v81, v163
  v_mul_f32 v82, v82, v163
  v_mul_f32 v83, v83, v163
  v_mul_f32 v84, v84, v163
  v_mul_f32 v85, v85, v163
  v_mul_f32 v86, v86, v163
  v_mul_f32 v87, v87, v163
  v_fmac_f32 v80, v16, v164
  v_fmac_f32 v81, v17, v164
  v_fmac_f32 v82, v18, v164
  v_fmac_f32 v83, v19, v164
  v_fmac_f32 v84, v20, v164
  v_fmac_f32 v85, v21, v164
  v_fmac_f32 v86, v22, v164
  v_fmac_f32 v87, v23, v164
  v_cvt_pk_bf16_f32 v8, v80, v81
  v_cvt_pk_bf16_f32 v9, v82, v83
  v_cvt_pk_bf16_f32 v10, v84, v85
  v_cvt_pk_bf16_f32 v11, v86, v87
  buffer_store_dwordx4 v[8:11], v167, s[36:39], s58 offen sc1
  s_setprio 3
  s_waitcnt vmcnt(1)
  v_bfe_u32 v148, v1, 2, 2
  v_lshlrev_b32 v148, 6, v148
  v_bfe_u32 v149, v1, 4, 1
  v_lshl_add_u32 v148, v149, 5, v148
  v_and_b32 v149, 3, v1
  v_lshl_add_u32 v148, v149, 3, v148
  v_lshrrev_b32 v149, 5, v1
  v_lshl_add_u32 v148, v149, 8, v148
  s_lshl_b32 s58, s55, 14
  s_add_u32 s58, s58, 65536
  v_add_u32 v148, s58, v148
  v_lshlrev_b32 v150, 8, v1
  s_lshl_b32 s61, s95, 3
  s_lshl_b32 s59, s55, 1
  s_add_u32 s61, s61, s59
  s_lshl_b32 s61, s61, 8
  s_add_u32 s61, s61, 12779520
  s_lshl_b32 s58, s95, 1
  s_add_u32 s58, s58, s56
  s_lshl_b32 s58, s58, 15
  s_lshl_b32 s59, s55, 13
  s_add_u32 s58, s58, s59
  s_add_u32 s58, s58, 0
  s_add_u32 s59, s58, 4096
  s_mov_b32 s70, 0x400000
Lsp78:
  ds_read_b32 v162, v2 offset:148
  s_sub_u32 s70, s70, 1
  s_cbranch_scc1 Lok79
  s_waitcnt lgkmcnt(0)
  v_readfirstlane_b32 s68, v162
  s_nop 0
  s_cmp_lt_u32 s68, 4
  s_cbranch_scc1 Lsp78
Lok79:
  s_waitcnt vmcnt(0)
  s_mov_b64 exec, 1
  ds_add_rtn_u32 v162, v2, v3 offset:132
  v_mov_b32 v164, s34
  v_mov_b32 v165, s35
  v_mov_b32 v163, 0
  s_waitcnt lgkmcnt(0)
  v_readfirstlane_b32 s68, v162
  s_nop 0
  s_cmp_lg_u32 s68, 7
  s_cbranch_scc1 Lpb80
  buffer_store_dwordx2 v[164:165], v163, s[36:39], s60 offen sc1
Lpb80:
  s_mov_b64 exec, -1
  ds_read_b64_tr_b16 v[20:21], v148 offset:0
  ds_read_b64_tr_b16 v[22:23], v148 offset:512
  ds_read_b64_tr_b16 v[24:25], v148 offset:1024
  ds_read_b64_tr_b16 v[26:27], v148 offset:1536
  ds_read_b64_tr_b16 v[28:29], v148 offset:2048
  ds_read_b64_tr_b16 v[30:31], v148 offset:2560
  ds_read_b64_tr_b16 v[32:33], v148 offset:3072
  ds_read_b64_tr_b16 v[34:35], v148 offset:3584
  ds_read_b64_tr_b16 v[36:37], v148 offset:4096
  ds_read_b64_tr_b16 v[38:39], v148 offset:4608
  ds_read_b64_tr_b16 v[40:41], v148 offset:5120
  ds_read_b64_tr_b16 v[42:43], v148 offset:5632
  ds_read_b64_tr_b16 v[44:45], v148 offset:6144
  ds_read_b64_tr_b16 v[46:47], v148 offset:6656
  ds_read_b64_tr_b16 v[48:49], v148 offset:7168
  ds_read_b64_tr_b16 v[50:51], v148 offset:7680
  ds_read_b64_tr_b16 v[52:53], v148 offset:8192
  ds_read_b64_tr_b16 v[54:55], v148 offset:8704
  ds_read_b64_tr_b16 v[56:57], v148 offset:9216
  ds_read_b64_tr_b16 v[58:59], v148 offset:9728
  ds_read_b64_tr_b16 v[60:61], v148 offset:10240
  ds_read_b64_tr_b16 v[62:63], v148 offset:10752
  ds_read_b64_tr_b16 v[64:65], v148 offset:11264
  ds_read_b64_tr_b16 v[66:67], v148 offset:11776
  ds_read_b64_tr_b16 v[68:69], v148 offset:12288
  ds_read_b64_tr_b16 v[70:71], v148 offset:12800
  ds_read_b64_tr_b16 v[72:73], v148 offset:13312
  ds_read_b64_tr_b16 v[74:75], v148 offset:13824
  ds_read_b64_tr_b16 v[76:77], v148 offset:14336
  ds_read_b64_tr_b16 v[78:79], v148 offset:14848
  ds_read_b64_tr_b16 v[80:81], v148 offset:15360
  ds_read_b64_tr_b16 v[82:83], v148 offset:15872
  s_mov_b32 s44, s28
  s_mov_b32 s45, s29
  s_mov_b32 s46, 4194304
  s_mov_b32 s47, 0x20000
  s_lshl_b32 s62, s55, 14
  s_lshl_b32 s63, s56, 13
  s_add_u32 s62, s62, s63
  v_and_b32 v151, 31, v1
  v_lshlrev_b32 v151, 8, v151
  v_add_u32 v151, s62, v151
  v_and_b32 v148, 7, v1
  v_xor_b32 v149, v148, v149
  v_xor_b32 v156, 0, v149
  v_lshl_add_u32 v152, v156, 4, v151
  v_xor_b32 v156, 2, v149
  v_lshl_add_u32 v153, v156, 4, v151
  v_xor_b32 v156, 4, v149
  v_lshl_add_u32 v154, v156, 4, v151
  v_xor_b32 v156, 6, v149
  v_lshl_add_u32 v155, v156, 4, v151
  v_lshrrev_b32 v149, 3, v1
  v_and_b32 v151, 3, v1
  v_lshlrev_b32 v151, 1, v151
  v_xor_b32 v151, v151, v149
  v_lshlrev_b32 v156, 8, v149
  v_bfe_u32 v157, v1, 2, 1
  v_lshl_add_u32 v156, v157, 7, v156
  s_lshl_b32 s62, s3, 11
  v_add_u32 v156, s62, v156
  v_lshl_add_u32 v157, v151, 4, v156
  v_xor_b32 v151, 1, v151
  v_lshl_add_u32 v158, v151, 4, v156
  v_lshlrev_b32 v148, 4, v148
  v_lshl_add_u32 v159, v149, 11, v148
  s_lshl_b32 s62, s95, 17
  s_lshl_b32 s63, s3, 14
  s_add_u32 s62, s62, s63
  s_lshl_b32 s63, s96, 7
  s_add_u32 s62, s62, s63
  s_mov_b32 s70, 0x40000
  s_mov_b32 exec_lo, 0x3
  s_mov_b32 exec_hi, 0x0
  s_branch Lpi84
Lpf81:
  s_sleep 1
Lpi84:
  buffer_load_dwordx2 v[162:163], v150, s[36:39], s61 offen sc1
Lpc83:
  s_sub_u32 s70, s70, 1
  s_cbranch_scc1 Lpk82
  s_waitcnt vmcnt(0)
  v_cmp_eq_u64 vcc, s[34:35], v[162:163]
  s_nop 3
  s_cmp_eq_u64 vcc, exec
  s_cbranch_scc0 Lpf81
Lpk82:
  s_mov_b64 exec, -1
  buffer_load_dwordx4 v[84:87], v167, s[36:39], s58 offen offset:0 sc1
  buffer_load_dwordx4 v[88:91], v167, s[36:39], s58 offen offset:1024 sc1
  buffer_load_dwordx4 v[92:95], v167, s[36:39], s58 offen offset:2048 sc1
  buffer_load_dwordx4 v[96:99], v167, s[36:39], s58 offen offset:3072 sc1
  buffer_load_dwordx4 v[100:103], v167, s[36:39], s59 offen offset:0 sc1
  buffer_load_dwordx4 v[104:107], v167, s[36:39], s59 offen offset:1024 sc1
  buffer_load_dwordx4 v[108:111], v167, s[36:39], s59 offen offset:2048 sc1
  buffer_load_dwordx4 v[112:115], v167, s[36:39], s59 offen offset:3072 sc1
  s_mov_b32 s70, 0x400000
Lsp85:
  s_sleep 1
  ds_read_b32 v162, v2 offset:132
  s_sub_u32 s70, s70, 1
  s_cbranch_scc1 Lok86
  s_waitcnt lgkmcnt(0)
  v_readfirstlane_b32 s68, v162
  s_nop 0
  s_cmp_lt_u32 s68, 8
  s_cbranch_scc1 Lsp85
Lok86:
  s_waitcnt vmcnt(7)
  v_mfma_f32_32x32x16_bf16 v[116:131], v[20:23], v[84:87], 0
  v_mfma_f32_32x32x16_bf16 v[132:147], v[24:27], v[84:87], 0
  s_waitcnt vmcnt(6)
  v_mfma_f32_32x32x16_bf16 v[116:131], v[28:31], v[88:91], v[116:131]
  v_mfma_f32_32x32x16_bf16 v[132:147], v[32:35], v[88:91], v[132:147]
  s_waitcnt vmcnt(5)
  v_mfma_f32_32x32x16_bf16 v[116:131], v[36:39], v[92:95], v[116:131]
  v_mfma_f32_32x32x16_bf16 v[132:147], v[40:43], v[92:95], v[132:147]
  s_waitcnt vmcnt(4)
  v_mfma_f32_32x32x16_bf16 v[116:131], v[44:47], v[96:99], v[116:131]
  v_mfma_f32_32x32x16_bf16 v[132:147], v[48:51], v[96:99], v[132:147]
  s_waitcnt vmcnt(3)
  v_mfma_f32_32x32x16_bf16 v[116:131], v[52:55], v[100:103], v[116:131]
  v_mfma_f32_32x32x16_bf16 v[132:147], v[56:59], v[100:103], v[132:147]
  s_waitcnt vmcnt(2)
  v_mfma_f32_32x32x16_bf16 v[116:131], v[60:63], v[104:107], v[116:131]
  v_mfma_f32_32x32x16_bf16 v[132:147], v[64:67], v[104:107], v[132:147]
  s_waitcnt vmcnt(1)
  v_mfma_f32_32x32x16_bf16 v[116:131], v[68:71], v[108:111], v[116:131]
  v_mfma_f32_32x32x16_bf16 v[132:147], v[72:75], v[108:111], v[132:147]
  s_waitcnt vmcnt(0)
  v_mfma_f32_32x32x16_bf16 v[116:131], v[76:79], v[112:115], v[116:131]
  v_mfma_f32_32x32x16_bf16 v[132:147], v[80:83], v[112:115], v[132:147]
  s_nop 10
  ds_write_b128 v152, v[116:119] offset:0
  ds_write_b128 v153, v[120:123] offset:0
  ds_write_b128 v154, v[124:127] offset:0
  ds_write_b128 v155, v[128:131] offset:0
  ds_write_b128 v152, v[132:135] offset:128
  ds_write_b128 v153, v[136:139] offset:128
  ds_write_b128 v154, v[140:143] offset:128
  ds_write_b128 v155, v[144:147] offset:128
  s_mov_b64 exec, 1
  ds_add_u32 v2, v3 offset:160
  s_mov_b64 exec, -1
  s_mov_b32 s70, 0x400000
Lsp87:
  ds_read_b32 v162, v2 offset:160
  s_sub_u32 s70, s70, 1
  s_cbranch_scc1 Lok88
  s_waitcnt lgkmcnt(0)
  v_readfirstlane_b32 s68, v162
  s_nop 0
  s_cmp_lt_u32 s68, 8
  s_cbranch_scc1 Lsp87
Lok88:
  ds_read_b128 v[16:19], v157 offset:0
  ds_read_b128 v[20:23], v158 offset:0
  ds_read_b128 v[24:27], v157 offset:16384
  ds_read_b128 v[28:31], v158 offset:16384
  ds_read_b128 v[32:35], v157 offset:32768
  ds_read_b128 v[36:39], v158 offset:32768
  ds_read_b128 v[40:43], v157 offset:49152
  ds_read_b128 v[44:47], v158 offset:49152
  s_waitcnt lgkmcnt(4)
  v_add_f32 v16, v16, v24
  v_add_f32 v17, v17, v25
  v_add_f32 v18, v18, v26
  v_add_f32 v19, v19, v27
  v_add_f32 v20, v20, v28
  v_add_f32 v21, v21, v29
  v_add_f32 v22, v22, v30
  v_add_f32 v23, v23, v31
  s_waitcnt lgkmcnt(0)
  v_add_f32 v32, v32, v40
  v_add_f32 v33, v33, v41
  v_add_f32 v34, v34, v42
  v_add_f32 v35, v35, v43
  v_add_f32 v36, v36, v44
  v_add_f32 v37, v37, v45
  v_add_f32 v38, v38, v46
  v_add_f32 v39, v39, v47
  v_add_f32 v16, v16, v32
  v_add_f32 v17, v17, v33
  v_add_f32 v18, v18, v34
  v_add_f32 v19, v19, v35
  v_add_f32 v20, v20, v36
  v_add_f32 v21, v21, v37
  v_add_f32 v22, v22, v38
  v_add_f32 v23, v23, v39
  v_cvt_pk_bf16_f32 v48, v16, v17
  v_cvt_pk_bf16_f32 v49, v18, v19
  v_cvt_pk_bf16_f32 v50, v20, v21
  v_cvt_pk_bf16_f32 v51, v22, v23
  buffer_store_dwordx4 v[48:51], v159, s[44:47], s62 offen sc1
  s_or_b32 s58, s2, s3
  s_cmp_lg_u32 s58, 0
  s_cbranch_scc1 L_noepoch
  v_mov_b32 v4, s34
  v_mov_b32 v5, s35
  v_mov_b32 v6, 12845056
  s_mov_b64 exec, 1
  buffer_store_dwordx2 v[4:5], v6, s[36:39], 0 offen sc1
L_noepoch:
  s_endpgm
L_stub:
  s_cmp_lg_u32 s65, s54
  s_cbranch_scc1 L_stub2
  s_setprio 0
  s_mov_b32 s54, 8
  s_lshl_b32 s58, s63, 4
  s_or_b32 s58, s58, s63
  s_lshr_b32 s66, s57, 1
  s_lshr_b32 s58, s58, s66
  s_not_b32 s58, s58
  s_and_b32 s58, s58, 15
  s_or_b32 s58, s58, 16
  s_ff1_i32_b32 s58, s58
  s_lshr_b32 s66, s58, 2
  s_lshl_b32 s58, s58, 1
  s_add_u32 s66, s66, s58
  s_sub_u32 s66, s66, 1
  s_max_i32 s66, s66, 1
  s_min_u32 s66, s66, s54
  s_cmp_lt_u32 s65, s66
  s_cbranch_scc1 L_loop
L_stub2:
  s_mov_b32 s70, 0x40000
L_stub3:
  v_lshlrev_b32 v164, 8, v1
  s_mov_b32 exec_lo, 0xffffffff
  s_mov_b32 exec_hi, 0x0
  buffer_load_dwordx2 v[162:163], v164, s[36:39], s53 offen sc1
  s_lshl_b32 s58, s56, 2
  s_waitcnt vmcnt(0)
  v_cmp_eq_u64 vcc, s[34:35], v[162:163]
  s_mov_b64 exec, -1
  s_nop 2
  s_lshr_b32 s63, vcc_lo, 1
  s_and_b32 s63, vcc_lo, s63
  s_lshr_b32 s63, s63, s58
  s_lshr_b32 s58, s63, 2
  s_and_b32 s63, s63, s58
  s_and_b32 s63, s63, 0x01010101
  s_mul_i32 s63, s63, 0x10204080
  s_lshr_b32 s63, s63, 28
  s_lshl_b32 s58, s63, 4
  s_or_b32 s58, s58, s63
  s_lshr_b32 s66, s57, 1
  s_lshr_b32 s58, s58, s66
  s_not_b32 s58, s58
  s_and_b32 s58, s58, 15
  s_or_b32 s58, s58, 16
  s_ff1_i32_b32 s58, s58
  s_lshr_b32 s66, s58, 2
  s_lshl_b32 s58, s58, 1
  s_add_u32 s66, s66, s58
  s_sub_u32 s66, s66, 1
  s_max_i32 s66, s66, 1
  s_min_u32 s66, s66, s54
  s_sub_u32 s70, s70, 1
  s_cbranch_scc1 L_loop
  s_cmp_lt_u32 s65, s66
  s_cbranch_scc1 L_loop
  s_sleep 4
  s_branch L_stub3
L_fallback:
  s_mov_b32 s64, 1
  s_mov_b32 s65, 0
  s_mov_b32 s61, s62
  v_mov_b32 v160, 0xff800000
  v_mov_b32 v161, 0xff800000
L_fb_loop:
  buffer_load_dwordx4 v[112:115], v5, s[36:39], s61 offen sc1
  s_add_u32 s61, s61, 0x400
  s_waitcnt vmcnt(0)
  v_mfma_f32_32x32x16_bf16 v[16:31], v[112:115], v[8:11], 0
  v_mfma_f32_32x32x16_bf16 v[32:47], v[112:115], v[12:15], 0
  s_nop 11
  v_max3_f32 v160, v160, v16, v17
  v_max3_f32 v160, v160, v18, v19
  v_max3_f32 v160, v160, v20, v21
  v_max3_f32 v160, v160, v22, v23
  v_max3_f32 v160, v160, v24, v25
  v_max3_f32 v160, v160, v26, v27
  v_max3_f32 v160, v160, v28, v29
  v_max3_f32 v160, v160, v30, v31
  v_max3_f32 v161, v161, v32, v33
  v_max3_f32 v161, v161, v34, v35
  v_max3_f32 v161, v161, v36, v37
  v_max3_f32 v161, v161, v38, v39
  v_max3_f32 v161, v161, v40, v41
  v_max3_f32 v161, v161, v42, v43
  v_max3_f32 v161, v161, v44, v45
  v_max3_f32 v161, v161, v46, v47
  s_add_u32 s65, s65, 1
  s_cmp_lt_u32 s65, 32
  s_cbranch_scc1 L_fb_loop
  s_lshl_b32 s58, s57, 12
  s_add_u32 s61, s62, s58
  buffer_load_dwordx4 v[112:115], v5, s[36:39], s61 offen offset:0 sc1
  buffer_load_dwordx4 v[116:119], v5, s[36:39], s61 offen offset:1024 sc1
  s_mov_b64 exec, s[50:51]
  buffer_load_dwordx4 v[128:131], v166, s[36:39], s61 offen offset:0 sc1
  buffer_load_dwordx4 v[132:135], v166, s[36:39], s61 offen offset:512 sc1
  s_mov_b64 exec, -1
  buffer_load_dwordx4 v[120:123], v5, s[36:39], s61 offen offset:2048 sc1
  s_mov_b64 exec, s[50:51]
  buffer_load_dwordx4 v[136:139], v166, s[36:39], s61 offen offset:1024 sc1
  buffer_load_dwordx4 v[140:143], v166, s[36:39], s61 offen offset:1536 sc1
  s_mov_b64 exec, -1
  buffer_load_dwordx4 v[124:127], v5, s[36:39], s61 offen offset:3072 sc1
  s_mov_b64 exec, s[50:51]
  buffer_load_dwordx4 v[144:147], v166, s[36:39], s61 offen offset:2048 sc1
  buffer_load_dwordx4 v[148:151], v166, s[36:39], s61 offen offset:2560 sc1
  s_mov_b64 exec, -1
  s_mov_b32 s59, s61
  s_add_u32 s61, s61, 4096
  s_add_u32 s67, s58, 4096
  v_mov_b32 v80, 0
  v_mov_b32 v81, 0
  v_mov_b32 v82, 0
  v_mov_b32 v83, 0
  v_mov_b32 v84, 0
  v_mov_b32 v85, 0
  v_mov_b32 v86, 0
  v_mov_b32 v87, 0
  v_mov_b32 v88, 0
  v_mov_b32 v96, 0
  v_mov_b32 v97, 0
  v_mov_b32 v98, 0
  v_mov_b32 v99, 0
  v_mov_b32 v100, 0
  v_mov_b32 v101, 0
  v_mov_b32 v102, 0
  v_mov_b32 v103, 0
  v_mov_b32 v104, 0
  s_branch L_start
.section .rodata,"a"
.p2align 6
.amdhsa_kernel fused_kernel
  .amdhsa_next_free_vgpr 168
  .amdhsa_next_free_sgpr 100
  .amdhsa_accum_offset 168
  .amdhsa_group_segment_fixed_size 0
  .amdhsa_kernarg_size 120
  .amdhsa_user_sgpr_count 2
  .amdhsa_user_sgpr_kernarg_segment_ptr 1
  .amdhsa_system_sgpr_workgroup_id_x 1
.end_amdhsa_kernel
```
